```python
import torch

def _softmax(x, axis=-1):
    return torch.softmax(x, dim=axis)
def _gelu(x):
    return torch.nn.functional.gelu(x, approximate="tanh")
def _silu(x):
    return torch.nn.functional.silu(x)
def _sigmoid(x):
    return torch.sigmoid(x)
def _layernorm(x, axis=-1, eps=1e-5):
    m = x.mean(dim=axis, keepdim=True)
    v = x.var(dim=axis, keepdim=True, unbiased=False)
    return (x - m) / torch.sqrt(v + eps)
def _scatter_add(tgt, idx, src, axis=0):
    return tgt.clone().index_add_(axis, idx, src)
def _segment_sum(src, seg, n):
    out = torch.zeros((n,) + src.shape[1:], dtype=src.dtype)
    return out.index_add_(0, seg, src)
def _pad(x, pw):
    flat = tuple(v for pair in reversed(pw) for v in pair)
    return torch.nn.functional.pad(x, flat)

kernel_name = 'concat_heads__gqa_block_cached__mha_block_cached__near_ridge'

def setup_inputs():

    _w = (lambda a: (lambda t: t.to(torch.bfloat16) if t.is_floating_point() else t)(torch.as_tensor(a)))
    def _A_setup():
        B, Sq, D = 8, 48, 512
        Hq, Hkv, Sk, Dh = 32, 8, 2048, 128
        assert Hq % Hkv == 0, (Hq, Hkv)
        return {
            "x": _w((lambda *s: torch.randn(*s, dtype=torch.bfloat16) * 0.8)(B, Sq, D)),
            "k_cache": _w((lambda *s: torch.randn(*s, dtype=torch.bfloat16) * 0.8)(B, Hkv, Sk, Dh)),
            "v_cache": _w((lambda *s: torch.randn(*s, dtype=torch.bfloat16) * 0.05)(B, Hkv, Sk, Dh)),
            "wq": _w((lambda *s: torch.randn(*s, dtype=torch.bfloat16) * 0.8)(D, Hq * Dh) * (D ** -0.5)),
            "wo": _w((lambda *s: torch.randn(*s, dtype=torch.bfloat16) * 0.05)(Hq * Dh, D) * ((Hq * Dh) ** -0.5)),
        }
    _A_in = _A_setup()

    def _B_setup():
        B, Sq, D = 8, 48, 512
        H, Sk, Dh = 32, 2048, 128
        return {
            "x": _w((lambda *s: torch.randn(*s, dtype=torch.bfloat16) * 0.8)(B, Sq, D)),
            "k_cache": _w((lambda *s: torch.randn(*s, dtype=torch.bfloat16) * 0.8)(B, H, Sk, Dh)),
            "v_cache": _w((lambda *s: torch.randn(*s, dtype=torch.bfloat16) * 0.05)(B, H, Sk, Dh)),
            "wq": _w((lambda *s: torch.randn(*s, dtype=torch.bfloat16) * 0.8)(D, H * Dh) * (D ** -0.5)),
            "wo": _w((lambda *s: torch.randn(*s, dtype=torch.bfloat16) * 0.05)(H * Dh, D) * ((H * Dh) ** -0.5)),
        }
    _B_in = _B_setup()

    return {
        "A_x": _A_in["x"],
        "A_k_cache": _A_in["k_cache"],
        "A_v_cache": _A_in["v_cache"],
        "A_wq": _A_in["wq"],
        "A_wo": _A_in["wo"],
        "B_x": _B_in["x"],
        "B_k_cache": _B_in["k_cache"],
        "B_v_cache": _B_in["v_cache"],
        "B_wq": _B_in["wq"],
        "B_wo": _B_in["wo"],
    }

def reference(A_x, A_k_cache, A_v_cache, A_wq, A_wo, B_x, B_k_cache, B_v_cache, B_wq, B_wo):
    def _A_ref(x, k_cache, v_cache, wq, wo):
        B, Sq, D = x.shape
        Hq, Dh = 32, 128
        Hkv = k_cache.shape[1]
        rep = Hq // Hkv
        q = (lambda x, *d: x.permute(*d))((x @ wq).reshape(B, Sq, Hq, Dh), 0, 2, 1, 3)
        k = (lambda x, n, axis: torch.repeat_interleave(x, n, dim=axis))(k_cache, rep, axis=1)
        v = (lambda x, n, axis: torch.repeat_interleave(x, n, dim=axis))(v_cache, rep, axis=1)
        scores = torch.einsum("bhqd,bhkd->bhqk", q, k) * (Dh ** -0.5)
        p = _softmax(scores, axis=-1)
        o = torch.einsum("bhqk,bhkd->bhqd", p, v)
        return (lambda x, *d: x.permute(*d))(o, 0, 2, 1, 3).reshape(B, Sq, Hq * Dh) @ wo

    def _B_ref(x, k_cache, v_cache, wq, wo):
        B, Sq, D = x.shape
        H, Dh = 32, 128
        q = (lambda x, *d: x.permute(*d))((x @ wq).reshape(B, Sq, H, Dh), 0, 2, 1, 3)
        scores = torch.einsum("bhqd,bhkd->bhqk", q, k_cache) * (Dh ** -0.5)
        p = _softmax(scores, axis=-1)
        o = torch.einsum("bhqk,bhkd->bhqd", p, v_cache)
        return (lambda x, *d: x.permute(*d))(o, 0, 2, 1, 3).reshape(B, Sq, H * Dh) @ wo

    a = _A_ref(A_x, A_k_cache, A_v_cache, A_wq, A_wo)
    b = _B_ref(B_x, B_k_cache, B_v_cache, B_wq, B_wo)
    return torch.concatenate([a, b], axis=-1)
```

```asm
; @launch grid=(512,1,1) block=(256,1,1) lds=81920
.amdgcn_target "amdgcn-amd-amdhsa--gfx950"
.text
.globl concat_heads__gqa_block_cached__mha_block_cached__near_ridge_kernel
.p2align 8
.type concat_heads__gqa_block_cached__mha_block_cached__near_ridge_kernel,@function
concat_heads__gqa_block_cached__mha_block_cached__near_ridge_kernel:
    s_cmp_ge_u32 s2, 512
    s_cbranch_scc1 K1_END
    s_load_dwordx8 s[36:43], s[0:1], 0
    s_load_dwordx8 s[44:51], s[0:1], 40
    s_load_dwordx4 s[68:71], s[0:1], 88
    s_load_dwordx2 s[72:73], s[0:1], 32
    s_load_dwordx2 s[74:75], s[0:1], 72
    s_load_dwordx2 s[66:67], s[0:1], 80
    s_lshr_b32 s62, s2, 8
    v_lshrrev_b32 v1, 6, v0
    v_and_b32 v0, 63, v0
    s_and_b32 s34, s2, 7
    s_lshr_b32 s35, s2, 3
    s_lshr_b32 s23, s35, 5
    s_and_b32 s35, s35, 31
    s_xor_b32 s23, s23, 1
    v_readfirstlane_b32 s20, v1
    s_lshr_b32 s21, s35, 2
    s_and_b32 s60, s35, 3
    s_lshl_b32 s54, s34, 2
    s_add_u32 s22, s54, s60
    s_lshl_b32 s58, s21, 3
    s_add_u32 s58, s58, s34
    s_lshl_b32 s55, s21, 5
    s_add_u32 s55, s55, s22
    s_mov_b32 s56, 499712
    s_cmp_eq_u32 s23, 1
    s_cselect_b32 s54, s55, s58
    s_mov_b32 s57, s35
    s_waitcnt lgkmcnt(0)
    s_cselect_b64 s[36:37], s[44:45], s[36:37]
    s_cselect_b64 s[38:39], s[46:47], s[38:39]
    s_cselect_b64 s[40:41], s[48:49], s[40:41]
    s_cselect_b64 s[42:43], s[50:51], s[42:43]
    s_lshl_b32 s54, s54, 19
    s_lshl_b32 s55, s20, 13
    s_add_u32 s54, s54, s55
    s_add_u32 s4, s38, s54
    s_addc_u32 s5, s39, 0
    s_mov_b32 s6, s56
    s_mov_b32 s7, 0x20000
    s_add_u32 s8, s40, s54
    s_addc_u32 s9, s41, 0
    s_mov_b32 s10, s56
    s_mov_b32 s11, 0x20000
    s_lshr_b32 s64, s21, 2
    s_lshl_b32 s64, s64, 1
    s_add_u32 s64, s64, s60
    s_add_u32 s64, s64, s20
    s_and_b32 s64, s64, 3
    s_and_b32 s65, s21, 3
    s_mul_i32 s54, s21, 49152
    s_lshl_b32 s55, s64, 8
    s_add_u32 s54, s54, s55
    s_add_u32 s12, s36, s54
    s_addc_u32 s13, s37, 0
    s_sub_u32 s14, 393216, s54
    s_mov_b32 s15, 0x20000
    s_lshl_b32 s54, s64, 20
    s_lshl_b32 s55, s22, 8
    s_add_u32 s54, s54, s55
    s_add_u32 s16, s42, s54
    s_addc_u32 s17, s43, 0
    s_sub_u32 s18, 4194304, s54
    s_mov_b32 s19, 0x20000
    s_lshl_b32 s27, s20, 13
    s_add_u32 s28, s27, 32768
    s_lshl_b32 s29, s20, 12
    s_add_u32 s29, s29, 65536
    v_lshrrev_b32 v1, 4, v0
    v_and_b32 v2, 15, v0
    v_xor_b32 v3, v2, v1
    v_xor_b32 v4, 0, v3
    v_lshlrev_b32 v4, 4, v4
    v_lshl_add_u32 v4, v1, 8, v4
    v_xor_b32 v5, 12, v3
    v_lshlrev_b32 v5, 4, v5
    v_lshl_add_u32 v5, v1, 8, v5
    v_xor_b32 v6, 8, v3
    v_lshlrev_b32 v6, 4, v6
    v_lshl_add_u32 v6, v1, 8, v6
    v_xor_b32 v7, 4, v3
    v_lshlrev_b32 v7, 4, v7
    v_lshl_add_u32 v7, v1, 8, v7
    v_mul_u32_u24 v3, 768, v1
    v_add_u32 v88, v4, v3
    v_add_u32 v89, v5, v3
    v_add_u32 v90, v6, v3
    v_add_u32 v91, v7, v3
    s_add_u32 m0, s28, 0
    s_mov_b32 s34, 0
    buffer_load_dwordx4 v88, s[12:15], s34 offen lds
    s_add_u32 m0, s28, 1024
    s_mov_b32 s34, 4096
    buffer_load_dwordx4 v89, s[12:15], s34 offen lds
    s_add_u32 m0, s28, 2048
    s_mov_b32 s34, 8192
    buffer_load_dwordx4 v90, s[12:15], s34 offen lds
    s_add_u32 m0, s28, 3072
    s_mov_b32 s34, 12288
    buffer_load_dwordx4 v91, s[12:15], s34 offen lds
    s_add_u32 m0, s28, 4096
    s_mov_b32 s34, 16384
    buffer_load_dwordx4 v88, s[12:15], s34 offen lds
    s_add_u32 m0, s28, 5120
    s_mov_b32 s34, 20480
    buffer_load_dwordx4 v89, s[12:15], s34 offen lds
    s_add_u32 m0, s28, 6144
    s_mov_b32 s34, 24576
    buffer_load_dwordx4 v90, s[12:15], s34 offen lds
    s_add_u32 m0, s28, 7168
    s_mov_b32 s34, 28672
    buffer_load_dwordx4 v91, s[12:15], s34 offen lds
    s_add_u32 m0, s29, 0
    s_mov_b32 s34, 32768
    buffer_load_dwordx4 v88, s[12:15], s34 offen lds
    s_add_u32 m0, s29, 1024
    s_mov_b32 s34, 36864
    buffer_load_dwordx4 v89, s[12:15], s34 offen lds
    s_add_u32 m0, s29, 2048
    s_mov_b32 s34, 40960
    buffer_load_dwordx4 v90, s[12:15], s34 offen lds
    s_add_u32 m0, s29, 3072
    s_mov_b32 s34, 45056
    buffer_load_dwordx4 v91, s[12:15], s34 offen lds
    v_add_u32 v3, 0, v1
    v_lshlrev_b32 v3, 1, v3
    v_xor_b32 v3, v2, v3
    v_lshlrev_b32 v3, 4, v3
    v_lshl_add_u32 v8, v1, 8, v3
    v_add_u32 v3, 4, v1
    v_lshlrev_b32 v3, 1, v3
    v_xor_b32 v3, v2, v3
    v_lshlrev_b32 v3, 4, v3
    v_lshl_add_u32 v9, v1, 8, v3
    v_and_b32 v3, 4, v2
    v_lshlrev_b32 v3, 1, v3
    v_xor_b32 v3, v2, v3
    v_xor_b32 v86, v1, v3
    v_lshlrev_b32 v86, 4, v86
    v_lshl_add_u32 v86, v2, 8, v86
    v_lshlrev_b32 v2, 4, v2
    v_lshl_add_u32 v2, v1, 16, v2
    s_add_u32 s63, s65, 0
    s_and_b32 s63, s63, 3
    s_lshl_b32 s63, s63, 18
    s_add_u32 s34, s63, 0
    buffer_load_dwordx4 v[10:13], v2, s[16:19], s34 offen
    s_add_u32 s34, s63, 8192
    buffer_load_dwordx4 v[14:17], v2, s[16:19], s34 offen
    s_add_u32 s34, s63, 16384
    buffer_load_dwordx4 v[18:21], v2, s[16:19], s34 offen
    s_add_u32 s34, s63, 24576
    buffer_load_dwordx4 v[22:25], v2, s[16:19], s34 offen
    s_add_u32 s34, s63, 32768
    buffer_load_dwordx4 v[26:29], v2, s[16:19], s34 offen
    s_add_u32 s34, s63, 40960
    buffer_load_dwordx4 v[30:33], v2, s[16:19], s34 offen
    s_add_u32 s34, s63, 49152
    buffer_load_dwordx4 v[34:37], v2, s[16:19], s34 offen
    s_add_u32 s34, s63, 57344
    buffer_load_dwordx4 v[38:41], v2, s[16:19], s34 offen
    s_add_u32 s63, s65, 1
    s_and_b32 s63, s63, 3
    s_lshl_b32 s63, s63, 18
    s_add_u32 s34, s63, 0
    buffer_load_dwordx4 v[42:45], v2, s[16:19], s34 offen
    s_add_u32 s34, s63, 8192
    buffer_load_dwordx4 v[46:49], v2, s[16:19], s34 offen
    s_add_u32 s34, s63, 16384
    buffer_load_dwordx4 v[50:53], v2, s[16:19], s34 offen
    s_add_u32 s34, s63, 24576
    buffer_load_dwordx4 v[54:57], v2, s[16:19], s34 offen
    s_add_u32 s34, s63, 32768
    buffer_load_dwordx4 v[58:61], v2, s[16:19], s34 offen
    s_add_u32 s34, s63, 40960
    buffer_load_dwordx4 v[62:65], v2, s[16:19], s34 offen
    s_add_u32 s34, s63, 49152
    buffer_load_dwordx4 v[66:69], v2, s[16:19], s34 offen
    s_add_u32 s34, s63, 57344
    buffer_load_dwordx4 v[70:73], v2, s[16:19], s34 offen
    s_add_u32 s63, s65, 2
    s_and_b32 s63, s63, 3
    s_lshl_b32 s63, s63, 18
    s_add_u32 s34, s63, 0
    buffer_load_dwordx4 v[184:187], v2, s[16:19], s34 offen
    s_add_u32 s34, s63, 8192
    buffer_load_dwordx4 v[188:191], v2, s[16:19], s34 offen
    s_add_u32 s34, s63, 16384
    buffer_load_dwordx4 v[192:195], v2, s[16:19], s34 offen
    s_add_u32 s34, s63, 24576
    buffer_load_dwordx4 v[196:199], v2, s[16:19], s34 offen
    s_add_u32 s34, s63, 32768
    buffer_load_dwordx4 v[200:203], v2, s[16:19], s34 offen
    s_add_u32 s34, s63, 40960
    buffer_load_dwordx4 v[204:207], v2, s[16:19], s34 offen
    s_add_u32 s34, s63, 49152
    buffer_load_dwordx4 v[208:211], v2, s[16:19], s34 offen
    s_add_u32 s34, s63, 57344
    buffer_load_dwordx4 v[212:215], v2, s[16:19], s34 offen
    s_add_u32 s63, s65, 3
    s_and_b32 s63, s63, 3
    s_lshl_b32 s63, s63, 18
    s_add_u32 s34, s63, 0
    buffer_load_dwordx4 v[216:219], v2, s[16:19], s34 offen
    s_add_u32 s34, s63, 8192
    buffer_load_dwordx4 v[220:223], v2, s[16:19], s34 offen
    s_add_u32 s34, s63, 16384
    buffer_load_dwordx4 v[224:227], v2, s[16:19], s34 offen
    s_add_u32 s34, s63, 24576
    buffer_load_dwordx4 v[228:231], v2, s[16:19], s34 offen
    s_add_u32 s34, s63, 32768
    buffer_load_dwordx4 v[232:235], v2, s[16:19], s34 offen
    s_add_u32 s34, s63, 40960
    buffer_load_dwordx4 v[236:239], v2, s[16:19], s34 offen
    s_add_u32 s34, s63, 49152
    buffer_load_dwordx4 v[240:243], v2, s[16:19], s34 offen
    s_add_u32 s34, s63, 57344
    buffer_load_dwordx4 v[244:247], v2, s[16:19], s34 offen
    s_cmp_eq_u32 s23, 1
    s_cselect_b32 s98, 0, s60
    s_mov_b32 s96, 0
    s_mov_b32 s97, 0
    s_lshl_b32 s24, s98, 15
    s_mov_b32 s25, s24
    s_cmp_eq_u32 s23, 1
    s_cbranch_scc1 K0_BF
    s_mov_b32 m0, s27
    s_add_u32 s34, s24, 0x1000
    buffer_load_dwordx4 v4, s[4:7], s24 offen offset:0 lds
    buffer_load_dwordx4 v5, s[4:7], s24 offen offset:1024 lds
    buffer_load_dwordx4 v6, s[4:7], s24 offen offset:2048 lds
    buffer_load_dwordx4 v7, s[4:7], s24 offen offset:3072 lds
    s_add_u32 m0, s27, 0x1000
    s_nop 0
    buffer_load_dwordx4 v4, s[4:7], s34 offen offset:0 lds
    buffer_load_dwordx4 v5, s[4:7], s34 offen offset:1024 lds
    buffer_load_dwordx4 v6, s[4:7], s34 offen offset:2048 lds
    buffer_load_dwordx4 v7, s[4:7], s34 offen offset:3072 lds
    s_add_u32 s96, s96, 1
    s_add_u32 s24, s96, s98
    s_and_b32 s24, s24, 3
    s_and_b32 s34, s96, 12
    s_or_b32 s24, s24, s34
    s_lshl_b32 s24, s24, 15
    s_branch K0_EF
K0_BF:
    s_mov_b32 m0, s27
    s_add_u32 s34, s24, 0x1000
    buffer_load_dwordx4 v4, s[4:7], s24 offen offset:0 nt lds
    buffer_load_dwordx4 v5, s[4:7], s24 offen offset:1024 nt lds
    buffer_load_dwordx4 v6, s[4:7], s24 offen offset:2048 nt lds
    buffer_load_dwordx4 v7, s[4:7], s24 offen offset:3072 nt lds
    s_add_u32 m0, s27, 0x1000
    s_nop 0
    buffer_load_dwordx4 v4, s[4:7], s34 offen offset:0 nt lds
    buffer_load_dwordx4 v5, s[4:7], s34 offen offset:1024 nt lds
    buffer_load_dwordx4 v6, s[4:7], s34 offen offset:2048 nt lds
    buffer_load_dwordx4 v7, s[4:7], s34 offen offset:3072 nt lds
    s_add_u32 s96, s96, 1
    s_add_u32 s24, s96, s98
    s_and_b32 s24, s24, 3
    s_and_b32 s34, s96, 12
    s_or_b32 s24, s24, s34
    s_lshl_b32 s24, s24, 15
K0_EF:
    s_mov_b32 s30, 0x3e0293ee
    s_mov_b32 s31, 0x43800000
    s_mov_b32 s32, 0x05040100
    s_mov_b32 s33, 0x07060302
    s_waitcnt vmcnt(32)
    s_add_u32 s63, s65, 0
    s_and_b32 s63, s63, 3
    s_lshl_b32 s63, s63, 6
    v_xor_b32 v3, s63, v86
    v_add_u32 v87, s28, v3
    v_add_u32 v3, s29, v3
    ds_read_b128 v[74:77], v87
    ds_read_b128 v[78:81], v87 offset:4096
    ds_read_b128 v[82:85], v3
    v_perm_b32 v248, v14, v10, s32
    v_perm_b32 v249, v22, v18, s32
    v_perm_b32 v250, v30, v26, s32
    v_perm_b32 v251, v38, v34, s32
    v_perm_b32 v252, v14, v10, s33
    v_perm_b32 v253, v22, v18, s33
    v_perm_b32 v254, v30, v26, s33
    v_perm_b32 v255, v38, v34, s33
    s_waitcnt lgkmcnt(0)
    v_mfma_f32_16x16x32_bf16 v[88:91], v[248:251], v[74:77], 0
    v_mfma_f32_16x16x32_bf16 v[92:95], v[248:251], v[78:81], 0
    v_mfma_f32_16x16x32_bf16 v[96:99], v[248:251], v[82:85], 0
    v_perm_b32 v248, v15, v11, s32
    v_perm_b32 v249, v23, v19, s32
    v_perm_b32 v250, v31, v27, s32
    v_perm_b32 v251, v39, v35, s32
    v_mfma_f32_16x16x32_bf16 v[100:103], v[252:255], v[74:77], 0
    v_mfma_f32_16x16x32_bf16 v[104:107], v[252:255], v[78:81], 0
    v_mfma_f32_16x16x32_bf16 v[108:111], v[252:255], v[82:85], 0
    v_perm_b32 v252, v15, v11, s33
    v_perm_b32 v253, v23, v19, s33
    v_perm_b32 v254, v31, v27, s33
    v_perm_b32 v255, v39, v35, s33
    v_mfma_f32_16x16x32_bf16 v[112:115], v[248:251], v[74:77], 0
    v_mfma_f32_16x16x32_bf16 v[116:119], v[248:251], v[78:81], 0
    v_mfma_f32_16x16x32_bf16 v[120:123], v[248:251], v[82:85], 0
    v_perm_b32 v248, v16, v12, s32
    v_perm_b32 v249, v24, v20, s32
    v_perm_b32 v250, v32, v28, s32
    v_perm_b32 v251, v40, v36, s32
    v_mfma_f32_16x16x32_bf16 v[124:127], v[252:255], v[74:77], 0
    v_mfma_f32_16x16x32_bf16 v[128:131], v[252:255], v[78:81], 0
    v_mfma_f32_16x16x32_bf16 v[132:135], v[252:255], v[82:85], 0
    v_perm_b32 v252, v16, v12, s33
    v_perm_b32 v253, v24, v20, s33
    v_perm_b32 v254, v32, v28, s33
    v_perm_b32 v255, v40, v36, s33
    v_mfma_f32_16x16x32_bf16 v[136:139], v[248:251], v[74:77], 0
    v_mfma_f32_16x16x32_bf16 v[140:143], v[248:251], v[78:81], 0
    v_mfma_f32_16x16x32_bf16 v[144:147], v[248:251], v[82:85], 0
    v_perm_b32 v248, v17, v13, s32
    v_perm_b32 v249, v25, v21, s32
    v_perm_b32 v250, v33, v29, s32
    v_perm_b32 v251, v41, v37, s32
    v_mfma_f32_16x16x32_bf16 v[148:151], v[252:255], v[74:77], 0
    v_mfma_f32_16x16x32_bf16 v[152:155], v[252:255], v[78:81], 0
    v_mfma_f32_16x16x32_bf16 v[156:159], v[252:255], v[82:85], 0
    v_perm_b32 v252, v17, v13, s33
    v_perm_b32 v253, v25, v21, s33
    v_perm_b32 v254, v33, v29, s33
    v_perm_b32 v255, v41, v37, s33
    v_mfma_f32_16x16x32_bf16 v[160:163], v[248:251], v[74:77], 0
    v_mfma_f32_16x16x32_bf16 v[164:167], v[248:251], v[78:81], 0
    v_mfma_f32_16x16x32_bf16 v[168:171], v[248:251], v[82:85], 0
    s_nop 1
    v_mfma_f32_16x16x32_bf16 v[172:175], v[252:255], v[74:77], 0
    v_mfma_f32_16x16x32_bf16 v[176:179], v[252:255], v[78:81], 0
    v_mfma_f32_16x16x32_bf16 v[180:183], v[252:255], v[82:85], 0
    s_waitcnt vmcnt(24)
    s_add_u32 s63, s65, 1
    s_and_b32 s63, s63, 3
    s_lshl_b32 s63, s63, 6
    v_xor_b32 v3, s63, v86
    v_add_u32 v87, s28, v3
    v_add_u32 v3, s29, v3
    ds_read_b128 v[74:77], v87
    ds_read_b128 v[78:81], v87 offset:4096
    ds_read_b128 v[82:85], v3
    v_perm_b32 v248, v46, v42, s32
    v_perm_b32 v249, v54, v50, s32
    v_perm_b32 v250, v62, v58, s32
    v_perm_b32 v251, v70, v66, s32
    v_perm_b32 v252, v46, v42, s33
    v_perm_b32 v253, v54, v50, s33
    v_perm_b32 v254, v62, v58, s33
    v_perm_b32 v255, v70, v66, s33
    s_waitcnt lgkmcnt(0)
    v_mfma_f32_16x16x32_bf16 v[88:91], v[248:251], v[74:77], v[88:91]
    v_mfma_f32_16x16x32_bf16 v[92:95], v[248:251], v[78:81], v[92:95]
    v_mfma_f32_16x16x32_bf16 v[96:99], v[248:251], v[82:85], v[96:99]
    v_perm_b32 v248, v47, v43, s32
    v_perm_b32 v249, v55, v51, s32
    v_perm_b32 v250, v63, v59, s32
    v_perm_b32 v251, v71, v67, s32
    v_mfma_f32_16x16x32_bf16 v[100:103], v[252:255], v[74:77], v[100:103]
    v_mfma_f32_16x16x32_bf16 v[104:107], v[252:255], v[78:81], v[104:107]
    v_mfma_f32_16x16x32_bf16 v[108:111], v[252:255], v[82:85], v[108:111]
    v_perm_b32 v252, v47, v43, s33
    v_perm_b32 v253, v55, v51, s33
    v_perm_b32 v254, v63, v59, s33
    v_perm_b32 v255, v71, v67, s33
    v_mfma_f32_16x16x32_bf16 v[112:115], v[248:251], v[74:77], v[112:115]
    v_mfma_f32_16x16x32_bf16 v[116:119], v[248:251], v[78:81], v[116:119]
    v_mfma_f32_16x16x32_bf16 v[120:123], v[248:251], v[82:85], v[120:123]
    v_perm_b32 v248, v48, v44, s32
    v_perm_b32 v249, v56, v52, s32
    v_perm_b32 v250, v64, v60, s32
    v_perm_b32 v251, v72, v68, s32
    v_mfma_f32_16x16x32_bf16 v[124:127], v[252:255], v[74:77], v[124:127]
    v_mfma_f32_16x16x32_bf16 v[128:131], v[252:255], v[78:81], v[128:131]
    v_mfma_f32_16x16x32_bf16 v[132:135], v[252:255], v[82:85], v[132:135]
    v_perm_b32 v252, v48, v44, s33
    v_perm_b32 v253, v56, v52, s33
    v_perm_b32 v254, v64, v60, s33
    v_perm_b32 v255, v72, v68, s33
    v_mfma_f32_16x16x32_bf16 v[136:139], v[248:251], v[74:77], v[136:139]
    v_mfma_f32_16x16x32_bf16 v[140:143], v[248:251], v[78:81], v[140:143]
    v_mfma_f32_16x16x32_bf16 v[144:147], v[248:251], v[82:85], v[144:147]
    v_perm_b32 v248, v49, v45, s32
    v_perm_b32 v249, v57, v53, s32
    v_perm_b32 v250, v65, v61, s32
    v_perm_b32 v251, v73, v69, s32
    v_mfma_f32_16x16x32_bf16 v[148:151], v[252:255], v[74:77], v[148:151]
    v_mfma_f32_16x16x32_bf16 v[152:155], v[252:255], v[78:81], v[152:155]
    v_mfma_f32_16x16x32_bf16 v[156:159], v[252:255], v[82:85], v[156:159]
    v_perm_b32 v252, v49, v45, s33
    v_perm_b32 v253, v57, v53, s33
    v_perm_b32 v254, v65, v61, s33
    v_perm_b32 v255, v73, v69, s33
    v_mfma_f32_16x16x32_bf16 v[160:163], v[248:251], v[74:77], v[160:163]
    v_mfma_f32_16x16x32_bf16 v[164:167], v[248:251], v[78:81], v[164:167]
    v_mfma_f32_16x16x32_bf16 v[168:171], v[248:251], v[82:85], v[168:171]
    s_nop 1
    v_mfma_f32_16x16x32_bf16 v[172:175], v[252:255], v[74:77], v[172:175]
    v_mfma_f32_16x16x32_bf16 v[176:179], v[252:255], v[78:81], v[176:179]
    v_mfma_f32_16x16x32_bf16 v[180:183], v[252:255], v[82:85], v[180:183]
    s_waitcnt vmcnt(16)
    s_add_u32 s63, s65, 2
    s_and_b32 s63, s63, 3
    s_lshl_b32 s63, s63, 6
    v_xor_b32 v3, s63, v86
    v_add_u32 v87, s28, v3
    v_add_u32 v3, s29, v3
    ds_read_b128 v[74:77], v87
    ds_read_b128 v[78:81], v87 offset:4096
    ds_read_b128 v[82:85], v3
    v_perm_b32 v248, v188, v184, s32
    v_perm_b32 v249, v196, v192, s32
    v_perm_b32 v250, v204, v200, s32
    v_perm_b32 v251, v212, v208, s32
    v_perm_b32 v252, v188, v184, s33
    v_perm_b32 v253, v196, v192, s33
    v_perm_b32 v254, v204, v200, s33
    v_perm_b32 v255, v212, v208, s33
    s_waitcnt lgkmcnt(0)
    v_mfma_f32_16x16x32_bf16 v[88:91], v[248:251], v[74:77], v[88:91]
    v_mfma_f32_16x16x32_bf16 v[92:95], v[248:251], v[78:81], v[92:95]
    v_mfma_f32_16x16x32_bf16 v[96:99], v[248:251], v[82:85], v[96:99]
    v_perm_b32 v248, v189, v185, s32
    v_perm_b32 v249, v197, v193, s32
    v_perm_b32 v250, v205, v201, s32
    v_perm_b32 v251, v213, v209, s32
    v_mfma_f32_16x16x32_bf16 v[100:103], v[252:255], v[74:77], v[100:103]
    v_mfma_f32_16x16x32_bf16 v[104:107], v[252:255], v[78:81], v[104:107]
    v_mfma_f32_16x16x32_bf16 v[108:111], v[252:255], v[82:85], v[108:111]
    v_perm_b32 v252, v189, v185, s33
    v_perm_b32 v253, v197, v193, s33
    v_perm_b32 v254, v205, v201, s33
    v_perm_b32 v255, v213, v209, s33
    v_mfma_f32_16x16x32_bf16 v[112:115], v[248:251], v[74:77], v[112:115]
    v_mfma_f32_16x16x32_bf16 v[116:119], v[248:251], v[78:81], v[116:119]
    v_mfma_f32_16x16x32_bf16 v[120:123], v[248:251], v[82:85], v[120:123]
    v_perm_b32 v248, v190, v186, s32
    v_perm_b32 v249, v198, v194, s32
    v_perm_b32 v250, v206, v202, s32
    v_perm_b32 v251, v214, v210, s32
    v_mfma_f32_16x16x32_bf16 v[124:127], v[252:255], v[74:77], v[124:127]
    v_mfma_f32_16x16x32_bf16 v[128:131], v[252:255], v[78:81], v[128:131]
    v_mfma_f32_16x16x32_bf16 v[132:135], v[252:255], v[82:85], v[132:135]
    v_perm_b32 v252, v190, v186, s33
    v_perm_b32 v253, v198, v194, s33
    v_perm_b32 v254, v206, v202, s33
    v_perm_b32 v255, v214, v210, s33
    v_mfma_f32_16x16x32_bf16 v[136:139], v[248:251], v[74:77], v[136:139]
    v_mfma_f32_16x16x32_bf16 v[140:143], v[248:251], v[78:81], v[140:143]
    v_mfma_f32_16x16x32_bf16 v[144:147], v[248:251], v[82:85], v[144:147]
    v_perm_b32 v248, v191, v187, s32
    v_perm_b32 v249, v199, v195, s32
    v_perm_b32 v250, v207, v203, s32
    v_perm_b32 v251, v215, v211, s32
    v_mfma_f32_16x16x32_bf16 v[148:151], v[252:255], v[74:77], v[148:151]
    v_mfma_f32_16x16x32_bf16 v[152:155], v[252:255], v[78:81], v[152:155]
    v_mfma_f32_16x16x32_bf16 v[156:159], v[252:255], v[82:85], v[156:159]
    v_perm_b32 v252, v191, v187, s33
    v_perm_b32 v253, v199, v195, s33
    v_perm_b32 v254, v207, v203, s33
    v_perm_b32 v255, v215, v211, s33
    v_mfma_f32_16x16x32_bf16 v[160:163], v[248:251], v[74:77], v[160:163]
    v_mfma_f32_16x16x32_bf16 v[164:167], v[248:251], v[78:81], v[164:167]
    v_mfma_f32_16x16x32_bf16 v[168:171], v[248:251], v[82:85], v[168:171]
    s_nop 1
    v_mfma_f32_16x16x32_bf16 v[172:175], v[252:255], v[74:77], v[172:175]
    v_mfma_f32_16x16x32_bf16 v[176:179], v[252:255], v[78:81], v[176:179]
    v_mfma_f32_16x16x32_bf16 v[180:183], v[252:255], v[82:85], v[180:183]
    s_waitcnt vmcnt(8)
    s_add_u32 s63, s65, 3
    s_and_b32 s63, s63, 3
    s_lshl_b32 s63, s63, 6
    v_xor_b32 v3, s63, v86
    v_add_u32 v87, s28, v3
    v_add_u32 v3, s29, v3
    ds_read_b128 v[74:77], v87
    ds_read_b128 v[78:81], v87 offset:4096
    ds_read_b128 v[82:85], v3
    v_perm_b32 v248, v220, v216, s32
    v_perm_b32 v249, v228, v224, s32
    v_perm_b32 v250, v236, v232, s32
    v_perm_b32 v251, v244, v240, s32
    v_perm_b32 v252, v220, v216, s33
    v_perm_b32 v253, v228, v224, s33
    v_perm_b32 v254, v236, v232, s33
    v_perm_b32 v255, v244, v240, s33
    s_waitcnt lgkmcnt(0)
    v_mfma_f32_16x16x32_bf16 v[88:91], v[248:251], v[74:77], v[88:91]
    v_mfma_f32_16x16x32_bf16 v[92:95], v[248:251], v[78:81], v[92:95]
    v_mfma_f32_16x16x32_bf16 v[96:99], v[248:251], v[82:85], v[96:99]
    v_perm_b32 v248, v221, v217, s32
    v_perm_b32 v249, v229, v225, s32
    v_perm_b32 v250, v237, v233, s32
    v_perm_b32 v251, v245, v241, s32
    v_mfma_f32_16x16x32_bf16 v[100:103], v[252:255], v[74:77], v[100:103]
    v_mfma_f32_16x16x32_bf16 v[104:107], v[252:255], v[78:81], v[104:107]
    v_mfma_f32_16x16x32_bf16 v[108:111], v[252:255], v[82:85], v[108:111]
    v_perm_b32 v252, v221, v217, s33
    v_perm_b32 v253, v229, v225, s33
    v_perm_b32 v254, v237, v233, s33
    v_perm_b32 v255, v245, v241, s33
    v_mfma_f32_16x16x32_bf16 v[112:115], v[248:251], v[74:77], v[112:115]
    v_mfma_f32_16x16x32_bf16 v[116:119], v[248:251], v[78:81], v[116:119]
    v_mfma_f32_16x16x32_bf16 v[120:123], v[248:251], v[82:85], v[120:123]
    v_perm_b32 v248, v222, v218, s32
    v_perm_b32 v249, v230, v226, s32
    v_perm_b32 v250, v238, v234, s32
    v_perm_b32 v251, v246, v242, s32
    v_mfma_f32_16x16x32_bf16 v[124:127], v[252:255], v[74:77], v[124:127]
    v_mfma_f32_16x16x32_bf16 v[128:131], v[252:255], v[78:81], v[128:131]
    v_mfma_f32_16x16x32_bf16 v[132:135], v[252:255], v[82:85], v[132:135]
    v_perm_b32 v252, v222, v218, s33
    v_perm_b32 v253, v230, v226, s33
    v_perm_b32 v254, v238, v234, s33
    v_perm_b32 v255, v246, v242, s33
    v_mfma_f32_16x16x32_bf16 v[136:139], v[248:251], v[74:77], v[136:139]
    v_mfma_f32_16x16x32_bf16 v[140:143], v[248:251], v[78:81], v[140:143]
    v_mfma_f32_16x16x32_bf16 v[144:147], v[248:251], v[82:85], v[144:147]
    v_perm_b32 v248, v223, v219, s32
    v_perm_b32 v249, v231, v227, s32
    v_perm_b32 v250, v239, v235, s32
    v_perm_b32 v251, v247, v243, s32
    v_mfma_f32_16x16x32_bf16 v[148:151], v[252:255], v[74:77], v[148:151]
    v_mfma_f32_16x16x32_bf16 v[152:155], v[252:255], v[78:81], v[152:155]
    v_mfma_f32_16x16x32_bf16 v[156:159], v[252:255], v[82:85], v[156:159]
    v_perm_b32 v252, v223, v219, s33
    v_perm_b32 v253, v231, v227, s33
    v_perm_b32 v254, v239, v235, s33
    v_perm_b32 v255, v247, v243, s33
    v_mfma_f32_16x16x32_bf16 v[160:163], v[248:251], v[74:77], v[160:163]
    v_mfma_f32_16x16x32_bf16 v[164:167], v[248:251], v[78:81], v[164:167]
    v_mfma_f32_16x16x32_bf16 v[168:171], v[248:251], v[82:85], v[168:171]
    s_nop 1
    v_mfma_f32_16x16x32_bf16 v[172:175], v[252:255], v[74:77], v[172:175]
    v_mfma_f32_16x16x32_bf16 v[176:179], v[252:255], v[78:81], v[176:179]
    v_mfma_f32_16x16x32_bf16 v[180:183], v[252:255], v[82:85], v[180:183]
    v_lshlrev_b32 v1, 4, v0
    v_add_u32 v3, 65536, v1
    s_nop 5
    s_cmp_eq_u32 s20, 0
    s_cbranch_scc0 QR_1
    ds_write_b128 v1, v[112:115] offset:32768
    ds_write_b128 v1, v[116:119] offset:33792
    ds_write_b128 v1, v[120:123] offset:34816
    ds_write_b128 v1, v[124:127] offset:35840
    ds_write_b128 v1, v[128:131] offset:36864
    ds_write_b128 v1, v[132:135] offset:37888
    ds_write_b128 v1, v[136:139] offset:38912
    ds_write_b128 v1, v[140:143] offset:39936
    ds_write_b128 v3, v[144:147] offset:0
    ds_write_b128 v3, v[148:151] offset:1024
    ds_write_b128 v3, v[152:155] offset:2048
    ds_write_b128 v3, v[156:159] offset:3072
    s_waitcnt lgkmcnt(0)
    s_barrier
    ds_read_b128 v[10:13], v1 offset:57344
    ds_read_b128 v[14:17], v1 offset:58368
    ds_read_b128 v[18:21], v1 offset:59392
    ds_read_b128 v[22:25], v1 offset:60416
    ds_read_b128 v[26:29], v1 offset:61440
    ds_read_b128 v[30:33], v1 offset:62464
    ds_read_b128 v[34:37], v1 offset:55296
    ds_read_b128 v[38:41], v1 offset:56320
    ds_read_b128 v[42:45], v3 offset:8192
    ds_read_b128 v[46:49], v3 offset:9216
    ds_read_b128 v[50:53], v3 offset:10240
    ds_read_b128 v[54:57], v3 offset:11264
    s_waitcnt lgkmcnt(6)
    v_add_f32 v88, v88, v10
    v_add_f32 v89, v89, v11
    v_add_f32 v90, v90, v12
    v_add_f32 v91, v91, v13
    v_add_f32 v92, v92, v14
    v_add_f32 v93, v93, v15
    v_add_f32 v94, v94, v16
    v_add_f32 v95, v95, v17
    v_add_f32 v96, v96, v18
    v_add_f32 v97, v97, v19
    v_add_f32 v98, v98, v20
    v_add_f32 v99, v99, v21
    v_add_f32 v100, v100, v22
    v_add_f32 v101, v101, v23
    v_add_f32 v102, v102, v24
    v_add_f32 v103, v103, v25
    v_add_f32 v104, v104, v26
    v_add_f32 v105, v105, v27
    v_add_f32 v106, v106, v28
    v_add_f32 v107, v107, v29
    v_add_f32 v108, v108, v30
    v_add_f32 v109, v109, v31
    v_add_f32 v110, v110, v32
    v_add_f32 v111, v111, v33
    s_waitcnt lgkmcnt(0)
    v_add_f32 v88, v88, v34
    v_add_f32 v89, v89, v35
    v_add_f32 v90, v90, v36
    v_add_f32 v91, v91, v37
    v_add_f32 v92, v92, v38
    v_add_f32 v93, v93, v39
    v_add_f32 v94, v94, v40
    v_add_f32 v95, v95, v41
    v_add_f32 v96, v96, v42
    v_add_f32 v97, v97, v43
    v_add_f32 v98, v98, v44
    v_add_f32 v99, v99, v45
    v_add_f32 v100, v100, v46
    v_add_f32 v101, v101, v47
    v_add_f32 v102, v102, v48
    v_add_f32 v103, v103, v49
    v_add_f32 v104, v104, v50
    v_add_f32 v105, v105, v51
    v_add_f32 v106, v106, v52
    v_add_f32 v107, v107, v53
    v_add_f32 v108, v108, v54
    v_add_f32 v109, v109, v55
    v_add_f32 v110, v110, v56
    v_add_f32 v111, v111, v57
    s_barrier
    ds_write_b128 v1, v[160:163] offset:32768
    ds_write_b128 v1, v[164:167] offset:33792
    ds_write_b128 v1, v[168:171] offset:34816
    ds_write_b128 v1, v[172:175] offset:35840
    ds_write_b128 v1, v[176:179] offset:36864
    ds_write_b128 v1, v[180:183] offset:37888
    s_waitcnt lgkmcnt(0)
    s_barrier
    ds_read_b128 v[10:13], v1 offset:40960
    ds_read_b128 v[14:17], v1 offset:41984
    ds_read_b128 v[18:21], v1 offset:43008
    ds_read_b128 v[22:25], v1 offset:44032
    ds_read_b128 v[26:29], v1 offset:45056
    ds_read_b128 v[30:33], v1 offset:46080
    s_waitcnt lgkmcnt(0)
    v_add_f32 v88, v88, v10
    v_add_f32 v89, v89, v11
    v_add_f32 v90, v90, v12
    v_add_f32 v91, v91, v13
    v_add_f32 v92, v92, v14
    v_add_f32 v93, v93, v15
    v_add_f32 v94, v94, v16
    v_add_f32 v95, v95, v17
    v_add_f32 v96, v96, v18
    v_add_f32 v97, v97, v19
    v_add_f32 v98, v98, v20
    v_add_f32 v99, v99, v21
    v_add_f32 v100, v100, v22
    v_add_f32 v101, v101, v23
    v_add_f32 v102, v102, v24
    v_add_f32 v103, v103, v25
    v_add_f32 v104, v104, v26
    v_add_f32 v105, v105, v27
    v_add_f32 v106, v106, v28
    v_add_f32 v107, v107, v29
    v_add_f32 v108, v108, v30
    v_add_f32 v109, v109, v31
    v_add_f32 v110, v110, v32
    v_add_f32 v111, v111, v33
    v_cvt_pk_bf16_f32 v10, v88, v100
    v_cvt_pk_bf16_f32 v11, v89, v101
    v_cvt_pk_bf16_f32 v12, v90, v102
    v_cvt_pk_bf16_f32 v13, v91, v103
    v_cvt_pk_bf16_f32 v14, v92, v104
    v_cvt_pk_bf16_f32 v15, v93, v105
    v_cvt_pk_bf16_f32 v16, v94, v106
    v_cvt_pk_bf16_f32 v17, v95, v107
    v_cvt_pk_bf16_f32 v18, v96, v108
    v_cvt_pk_bf16_f32 v19, v97, v109
    v_cvt_pk_bf16_f32 v20, v98, v110
    v_cvt_pk_bf16_f32 v21, v99, v111
    ds_write_b32 v3, v10 offset:0
    ds_write_b32 v3, v11 offset:1024
    ds_write_b32 v3, v12 offset:2048
    ds_write_b32 v3, v13 offset:3072
    ds_write_b32 v3, v14 offset:4096
    ds_write_b32 v3, v15 offset:5120
    ds_write_b32 v3, v16 offset:6144
    ds_write_b32 v3, v17 offset:7168
    ds_write_b32 v3, v18 offset:8192
    ds_write_b32 v3, v19 offset:9216
    ds_write_b32 v3, v20 offset:10240
    ds_write_b32 v3, v21 offset:11264
    s_branch QR_END
QR_1:
    s_cmp_eq_u32 s20, 1
    s_cbranch_scc0 QR_2
    ds_write_b128 v1, v[136:139] offset:40960
    ds_write_b128 v1, v[140:143] offset:41984
    ds_write_b128 v1, v[144:147] offset:43008
    ds_write_b128 v1, v[148:151] offset:44032
    ds_write_b128 v1, v[152:155] offset:45056
    ds_write_b128 v1, v[156:159] offset:46080
    ds_write_b128 v1, v[160:163] offset:47104
    ds_write_b128 v1, v[164:167] offset:48128
    ds_write_b128 v3, v[168:171] offset:4096
    ds_write_b128 v3, v[172:175] offset:5120
    ds_write_b128 v3, v[176:179] offset:6144
    ds_write_b128 v3, v[180:183] offset:7168
    s_waitcnt lgkmcnt(0)
    s_barrier
    ds_read_b128 v[10:13], v1 offset:32768
    ds_read_b128 v[14:17], v1 offset:33792
    ds_read_b128 v[18:21], v1 offset:34816
    ds_read_b128 v[22:25], v1 offset:35840
    ds_read_b128 v[26:29], v1 offset:36864
    ds_read_b128 v[30:33], v1 offset:37888
    ds_read_b128 v[34:37], v1 offset:63488
    ds_read_b128 v[38:41], v1 offset:64512
    ds_read_b128 v[42:45], v3 offset:12288
    ds_read_b128 v[46:49], v3 offset:13312
    ds_read_b128 v[50:53], v3 offset:14336
    ds_read_b128 v[54:57], v3 offset:15360
    s_waitcnt lgkmcnt(6)
    v_add_f32 v112, v112, v10
    v_add_f32 v113, v113, v11
    v_add_f32 v114, v114, v12
    v_add_f32 v115, v115, v13
    v_add_f32 v116, v116, v14
    v_add_f32 v117, v117, v15
    v_add_f32 v118, v118, v16
    v_add_f32 v119, v119, v17
    v_add_f32 v120, v120, v18
    v_add_f32 v121, v121, v19
    v_add_f32 v122, v122, v20
    v_add_f32 v123, v123, v21
    v_add_f32 v124, v124, v22
    v_add_f32 v125, v125, v23
    v_add_f32 v126, v126, v24
    v_add_f32 v127, v127, v25
    v_add_f32 v128, v128, v26
    v_add_f32 v129, v129, v27
    v_add_f32 v130, v130, v28
    v_add_f32 v131, v131, v29
    v_add_f32 v132, v132, v30
    v_add_f32 v133, v133, v31
    v_add_f32 v134, v134, v32
    v_add_f32 v135, v135, v33
    s_waitcnt lgkmcnt(0)
    v_add_f32 v112, v112, v34
    v_add_f32 v113, v113, v35
    v_add_f32 v114, v114, v36
    v_add_f32 v115, v115, v37
    v_add_f32 v116, v116, v38
    v_add_f32 v117, v117, v39
    v_add_f32 v118, v118, v40
    v_add_f32 v119, v119, v41
    v_add_f32 v120, v120, v42
    v_add_f32 v121, v121, v43
    v_add_f32 v122, v122, v44
    v_add_f32 v123, v123, v45
    v_add_f32 v124, v124, v46
    v_add_f32 v125, v125, v47
    v_add_f32 v126, v126, v48
    v_add_f32 v127, v127, v49
    v_add_f32 v128, v128, v50
    v_add_f32 v129, v129, v51
    v_add_f32 v130, v130, v52
    v_add_f32 v131, v131, v53
    v_add_f32 v132, v132, v54
    v_add_f32 v133, v133, v55
    v_add_f32 v134, v134, v56
    v_add_f32 v135, v135, v57
    s_barrier
    ds_write_b128 v1, v[88:91] offset:40960
    ds_write_b128 v1, v[92:95] offset:41984
    ds_write_b128 v1, v[96:99] offset:43008
    ds_write_b128 v1, v[100:103] offset:44032
    ds_write_b128 v1, v[104:107] offset:45056
    ds_write_b128 v1, v[108:111] offset:46080
    s_waitcnt lgkmcnt(0)
    s_barrier
    ds_read_b128 v[10:13], v1 offset:49152
    ds_read_b128 v[14:17], v1 offset:50176
    ds_read_b128 v[18:21], v1 offset:51200
    ds_read_b128 v[22:25], v1 offset:52224
    ds_read_b128 v[26:29], v1 offset:53248
    ds_read_b128 v[30:33], v1 offset:54272
    s_waitcnt lgkmcnt(0)
    v_add_f32 v112, v112, v10
    v_add_f32 v113, v113, v11
    v_add_f32 v114, v114, v12
    v_add_f32 v115, v115, v13
    v_add_f32 v116, v116, v14
    v_add_f32 v117, v117, v15
    v_add_f32 v118, v118, v16
    v_add_f32 v119, v119, v17
    v_add_f32 v120, v120, v18
    v_add_f32 v121, v121, v19
    v_add_f32 v122, v122, v20
    v_add_f32 v123, v123, v21
    v_add_f32 v124, v124, v22
    v_add_f32 v125, v125, v23
    v_add_f32 v126, v126, v24
    v_add_f32 v127, v127, v25
    v_add_f32 v128, v128, v26
    v_add_f32 v129, v129, v27
    v_add_f32 v130, v130, v28
    v_add_f32 v131, v131, v29
    v_add_f32 v132, v132, v30
    v_add_f32 v133, v133, v31
    v_add_f32 v134, v134, v32
    v_add_f32 v135, v135, v33
    v_cvt_pk_bf16_f32 v10, v112, v124
    v_cvt_pk_bf16_f32 v11, v113, v125
    v_cvt_pk_bf16_f32 v12, v114, v126
    v_cvt_pk_bf16_f32 v13, v115, v127
    v_cvt_pk_bf16_f32 v14, v116, v128
    v_cvt_pk_bf16_f32 v15, v117, v129
    v_cvt_pk_bf16_f32 v16, v118, v130
    v_cvt_pk_bf16_f32 v17, v119, v131
    v_cvt_pk_bf16_f32 v18, v120, v132
    v_cvt_pk_bf16_f32 v19, v121, v133
    v_cvt_pk_bf16_f32 v20, v122, v134
    v_cvt_pk_bf16_f32 v21, v123, v135
    ds_write_b32 v3, v10 offset:4
    ds_write_b32 v3, v11 offset:1028
    ds_write_b32 v3, v12 offset:2052
    ds_write_b32 v3, v13 offset:3076
    ds_write_b32 v3, v14 offset:4100
    ds_write_b32 v3, v15 offset:5124
    ds_write_b32 v3, v16 offset:6148
    ds_write_b32 v3, v17 offset:7172
    ds_write_b32 v3, v18 offset:8196
    ds_write_b32 v3, v19 offset:9220
    ds_write_b32 v3, v20 offset:10244
    ds_write_b32 v3, v21 offset:11268
    s_branch QR_END
QR_2:
    s_cmp_eq_u32 s20, 2
    s_cbranch_scc0 QR_3
    ds_write_b128 v1, v[160:163] offset:49152
    ds_write_b128 v1, v[164:167] offset:50176
    ds_write_b128 v1, v[168:171] offset:51200
    ds_write_b128 v1, v[172:175] offset:52224
    ds_write_b128 v1, v[176:179] offset:53248
    ds_write_b128 v1, v[180:183] offset:54272
    ds_write_b128 v1, v[88:91] offset:55296
    ds_write_b128 v1, v[92:95] offset:56320
    ds_write_b128 v3, v[96:99] offset:8192
    ds_write_b128 v3, v[100:103] offset:9216
    ds_write_b128 v3, v[104:107] offset:10240
    ds_write_b128 v3, v[108:111] offset:11264
    s_waitcnt lgkmcnt(0)
    s_barrier
    ds_read_b128 v[10:13], v1 offset:40960
    ds_read_b128 v[14:17], v1 offset:41984
    ds_read_b128 v[18:21], v1 offset:43008
    ds_read_b128 v[22:25], v1 offset:44032
    ds_read_b128 v[26:29], v1 offset:45056
    ds_read_b128 v[30:33], v1 offset:46080
    ds_read_b128 v[34:37], v1 offset:38912
    ds_read_b128 v[38:41], v1 offset:39936
    ds_read_b128 v[42:45], v3 offset:0
    ds_read_b128 v[46:49], v3 offset:1024
    ds_read_b128 v[50:53], v3 offset:2048
    ds_read_b128 v[54:57], v3 offset:3072
    s_waitcnt lgkmcnt(6)
    v_add_f32 v136, v136, v10
    v_add_f32 v137, v137, v11
    v_add_f32 v138, v138, v12
    v_add_f32 v139, v139, v13
    v_add_f32 v140, v140, v14
    v_add_f32 v141, v141, v15
    v_add_f32 v142, v142, v16
    v_add_f32 v143, v143, v17
    v_add_f32 v144, v144, v18
    v_add_f32 v145, v145, v19
    v_add_f32 v146, v146, v20
    v_add_f32 v147, v147, v21
    v_add_f32 v148, v148, v22
    v_add_f32 v149, v149, v23
    v_add_f32 v150, v150, v24
    v_add_f32 v151, v151, v25
    v_add_f32 v152, v152, v26
    v_add_f32 v153, v153, v27
    v_add_f32 v154, v154, v28
    v_add_f32 v155, v155, v29
    v_add_f32 v156, v156, v30
    v_add_f32 v157, v157, v31
    v_add_f32 v158, v158, v32
    v_add_f32 v159, v159, v33
    s_waitcnt lgkmcnt(0)
    v_add_f32 v136, v136, v34
    v_add_f32 v137, v137, v35
    v_add_f32 v138, v138, v36
    v_add_f32 v139, v139, v37
    v_add_f32 v140, v140, v38
    v_add_f32 v141, v141, v39
    v_add_f32 v142, v142, v40
    v_add_f32 v143, v143, v41
    v_add_f32 v144, v144, v42
    v_add_f32 v145, v145, v43
    v_add_f32 v146, v146, v44
    v_add_f32 v147, v147, v45
    v_add_f32 v148, v148, v46
    v_add_f32 v149, v149, v47
    v_add_f32 v150, v150, v48
    v_add_f32 v151, v151, v49
    v_add_f32 v152, v152, v50
    v_add_f32 v153, v153, v51
    v_add_f32 v154, v154, v52
    v_add_f32 v155, v155, v53
    v_add_f32 v156, v156, v54
    v_add_f32 v157, v157, v55
    v_add_f32 v158, v158, v56
    v_add_f32 v159, v159, v57
    s_barrier
    ds_write_b128 v1, v[112:115] offset:49152
    ds_write_b128 v1, v[116:119] offset:50176
    ds_write_b128 v1, v[120:123] offset:51200
    ds_write_b128 v1, v[124:127] offset:52224
    ds_write_b128 v1, v[128:131] offset:53248
    ds_write_b128 v1, v[132:135] offset:54272
    s_waitcnt lgkmcnt(0)
    s_barrier
    ds_read_b128 v[10:13], v1 offset:57344
    ds_read_b128 v[14:17], v1 offset:58368
    ds_read_b128 v[18:21], v1 offset:59392
    ds_read_b128 v[22:25], v1 offset:60416
    ds_read_b128 v[26:29], v1 offset:61440
    ds_read_b128 v[30:33], v1 offset:62464
    s_waitcnt lgkmcnt(0)
    v_add_f32 v136, v136, v10
    v_add_f32 v137, v137, v11
    v_add_f32 v138, v138, v12
    v_add_f32 v139, v139, v13
    v_add_f32 v140, v140, v14
    v_add_f32 v141, v141, v15
    v_add_f32 v142, v142, v16
    v_add_f32 v143, v143, v17
    v_add_f32 v144, v144, v18
    v_add_f32 v145, v145, v19
    v_add_f32 v146, v146, v20
    v_add_f32 v147, v147, v21
    v_add_f32 v148, v148, v22
    v_add_f32 v149, v149, v23
    v_add_f32 v150, v150, v24
    v_add_f32 v151, v151, v25
    v_add_f32 v152, v152, v26
    v_add_f32 v153, v153, v27
    v_add_f32 v154, v154, v28
    v_add_f32 v155, v155, v29
    v_add_f32 v156, v156, v30
    v_add_f32 v157, v157, v31
    v_add_f32 v158, v158, v32
    v_add_f32 v159, v159, v33
    v_cvt_pk_bf16_f32 v10, v136, v148
    v_cvt_pk_bf16_f32 v11, v137, v149
    v_cvt_pk_bf16_f32 v12, v138, v150
    v_cvt_pk_bf16_f32 v13, v139, v151
    v_cvt_pk_bf16_f32 v14, v140, v152
    v_cvt_pk_bf16_f32 v15, v141, v153
    v_cvt_pk_bf16_f32 v16, v142, v154
    v_cvt_pk_bf16_f32 v17, v143, v155
    v_cvt_pk_bf16_f32 v18, v144, v156
    v_cvt_pk_bf16_f32 v19, v145, v157
    v_cvt_pk_bf16_f32 v20, v146, v158
    v_cvt_pk_bf16_f32 v21, v147, v159
    ds_write_b32 v3, v10 offset:8
    ds_write_b32 v3, v11 offset:1032
    ds_write_b32 v3, v12 offset:2056
    ds_write_b32 v3, v13 offset:3080
    ds_write_b32 v3, v14 offset:4104
    ds_write_b32 v3, v15 offset:5128
    ds_write_b32 v3, v16 offset:6152
    ds_write_b32 v3, v17 offset:7176
    ds_write_b32 v3, v18 offset:8200
    ds_write_b32 v3, v19 offset:9224
    ds_write_b32 v3, v20 offset:10248
    ds_write_b32 v3, v21 offset:11272
    s_branch QR_END
QR_3:
    ds_write_b128 v1, v[88:91] offset:57344
    ds_write_b128 v1, v[92:95] offset:58368
    ds_write_b128 v1, v[96:99] offset:59392
    ds_write_b128 v1, v[100:103] offset:60416
    ds_write_b128 v1, v[104:107] offset:61440
    ds_write_b128 v1, v[108:111] offset:62464
    ds_write_b128 v1, v[112:115] offset:63488
    ds_write_b128 v1, v[116:119] offset:64512
    ds_write_b128 v3, v[120:123] offset:12288
    ds_write_b128 v3, v[124:127] offset:13312
    ds_write_b128 v3, v[128:131] offset:14336
    ds_write_b128 v3, v[132:135] offset:15360
    s_waitcnt lgkmcnt(0)
    s_barrier
    ds_read_b128 v[10:13], v1 offset:49152
    ds_read_b128 v[14:17], v1 offset:50176
    ds_read_b128 v[18:21], v1 offset:51200
    ds_read_b128 v[22:25], v1 offset:52224
    ds_read_b128 v[26:29], v1 offset:53248
    ds_read_b128 v[30:33], v1 offset:54272
    ds_read_b128 v[34:37], v1 offset:47104
    ds_read_b128 v[38:41], v1 offset:48128
    ds_read_b128 v[42:45], v3 offset:4096
    ds_read_b128 v[46:49], v3 offset:5120
    ds_read_b128 v[50:53], v3 offset:6144
    ds_read_b128 v[54:57], v3 offset:7168
    s_waitcnt lgkmcnt(6)
    v_add_f32 v160, v160, v10
    v_add_f32 v161, v161, v11
    v_add_f32 v162, v162, v12
    v_add_f32 v163, v163, v13
    v_add_f32 v164, v164, v14
    v_add_f32 v165, v165, v15
    v_add_f32 v166, v166, v16
    v_add_f32 v167, v167, v17
    v_add_f32 v168, v168, v18
    v_add_f32 v169, v169, v19
    v_add_f32 v170, v170, v20
    v_add_f32 v171, v171, v21
    v_add_f32 v172, v172, v22
    v_add_f32 v173, v173, v23
    v_add_f32 v174, v174, v24
    v_add_f32 v175, v175, v25
    v_add_f32 v176, v176, v26
    v_add_f32 v177, v177, v27
    v_add_f32 v178, v178, v28
    v_add_f32 v179, v179, v29
    v_add_f32 v180, v180, v30
    v_add_f32 v181, v181, v31
    v_add_f32 v182, v182, v32
    v_add_f32 v183, v183, v33
    s_waitcnt lgkmcnt(0)
    v_add_f32 v160, v160, v34
    v_add_f32 v161, v161, v35
    v_add_f32 v162, v162, v36
    v_add_f32 v163, v163, v37
    v_add_f32 v164, v164, v38
    v_add_f32 v165, v165, v39
    v_add_f32 v166, v166, v40
    v_add_f32 v167, v167, v41
    v_add_f32 v168, v168, v42
    v_add_f32 v169, v169, v43
    v_add_f32 v170, v170, v44
    v_add_f32 v171, v171, v45
    v_add_f32 v172, v172, v46
    v_add_f32 v173, v173, v47
    v_add_f32 v174, v174, v48
    v_add_f32 v175, v175, v49
    v_add_f32 v176, v176, v50
    v_add_f32 v177, v177, v51
    v_add_f32 v178, v178, v52
    v_add_f32 v179, v179, v53
    v_add_f32 v180, v180, v54
    v_add_f32 v181, v181, v55
    v_add_f32 v182, v182, v56
    v_add_f32 v183, v183, v57
    s_barrier
    ds_write_b128 v1, v[136:139] offset:57344
    ds_write_b128 v1, v[140:143] offset:58368
    ds_write_b128 v1, v[144:147] offset:59392
    ds_write_b128 v1, v[148:151] offset:60416
    ds_write_b128 v1, v[152:155] offset:61440
    ds_write_b128 v1, v[156:159] offset:62464
    s_waitcnt lgkmcnt(0)
    s_barrier
    ds_read_b128 v[10:13], v1 offset:32768
    ds_read_b128 v[14:17], v1 offset:33792
    ds_read_b128 v[18:21], v1 offset:34816
    ds_read_b128 v[22:25], v1 offset:35840
    ds_read_b128 v[26:29], v1 offset:36864
    ds_read_b128 v[30:33], v1 offset:37888
    s_waitcnt lgkmcnt(0)
    v_add_f32 v160, v160, v10
    v_add_f32 v161, v161, v11
    v_add_f32 v162, v162, v12
    v_add_f32 v163, v163, v13
    v_add_f32 v164, v164, v14
    v_add_f32 v165, v165, v15
    v_add_f32 v166, v166, v16
    v_add_f32 v167, v167, v17
    v_add_f32 v168, v168, v18
    v_add_f32 v169, v169, v19
    v_add_f32 v170, v170, v20
    v_add_f32 v171, v171, v21
    v_add_f32 v172, v172, v22
    v_add_f32 v173, v173, v23
    v_add_f32 v174, v174, v24
    v_add_f32 v175, v175, v25
    v_add_f32 v176, v176, v26
    v_add_f32 v177, v177, v27
    v_add_f32 v178, v178, v28
    v_add_f32 v179, v179, v29
    v_add_f32 v180, v180, v30
    v_add_f32 v181, v181, v31
    v_add_f32 v182, v182, v32
    v_add_f32 v183, v183, v33
    v_cvt_pk_bf16_f32 v10, v160, v172
    v_cvt_pk_bf16_f32 v11, v161, v173
    v_cvt_pk_bf16_f32 v12, v162, v174
    v_cvt_pk_bf16_f32 v13, v163, v175
    v_cvt_pk_bf16_f32 v14, v164, v176
    v_cvt_pk_bf16_f32 v15, v165, v177
    v_cvt_pk_bf16_f32 v16, v166, v178
    v_cvt_pk_bf16_f32 v17, v167, v179
    v_cvt_pk_bf16_f32 v18, v168, v180
    v_cvt_pk_bf16_f32 v19, v169, v181
    v_cvt_pk_bf16_f32 v20, v170, v182
    v_cvt_pk_bf16_f32 v21, v171, v183
    ds_write_b32 v3, v10 offset:12
    ds_write_b32 v3, v11 offset:1036
    ds_write_b32 v3, v12 offset:2060
    ds_write_b32 v3, v13 offset:3084
    ds_write_b32 v3, v14 offset:4108
    ds_write_b32 v3, v15 offset:5132
    ds_write_b32 v3, v16 offset:6156
    ds_write_b32 v3, v17 offset:7180
    ds_write_b32 v3, v18 offset:8204
    ds_write_b32 v3, v19 offset:9228
    ds_write_b32 v3, v20 offset:10252
    ds_write_b32 v3, v21 offset:11276
QR_END:
    s_waitcnt lgkmcnt(0)
    s_barrier
    s_cmp_eq_u32 s62, 0
    s_cbranch_scc1 RS_SKIP
    s_cmp_lg_u32 s20, 0
    s_cbranch_scc1 RS_SKIP
    v_lshlrev_b32 v249, 2, v0
    s_and_b32 s54, s2, 7
    s_lshr_b32 s55, s2, 3
    s_and_b32 s55, s55, 31
    s_lshr_b32 s36, s54, 2
    s_lshr_b32 s37, s54, 1
    s_and_b32 s37, s37, 1
    s_lshl_b32 s37, s37, 2
    s_lshr_b32 s38, s55, 3
    s_add_u32 s37, s37, s38
    s_and_b32 s38, s54, 1
    s_lshl_b32 s38, s38, 2
    s_lshr_b32 s39, s55, 1
    s_and_b32 s39, s39, 3
    s_add_u32 s38, s38, s39
    s_and_b32 s39, s55, 1
    s_lshl_b32 s56, s36, 3
    s_add_u32 s56, s56, s37
    s_lshl_b32 s56, s56, 7
    s_lshl_b32 s54, s39, 6
    s_add_u32 s57, s56, s54
    s_add_u32 s57, s57, 41943040
    s_add_u32 s12, s70, s57
    s_addc_u32 s13, s71, 0
    s_mov_b32 s14, 64
    s_mov_b32 s15, 0x20000
    buffer_load_dword v253, v249, s[12:15], 0 offen sc1
    s_lshl_b32 s56, s36, 3
    s_add_u32 s56, s56, s37
    s_lshl_b32 s56, s56, 3
    s_add_u32 s56, s56, s38
    s_lshl_b32 s56, s56, 7
    s_add_u32 s57, s56, 32768
    s_add_u32 s57, s57, 41943040
    s_add_u32 s12, s70, s57
    s_addc_u32 s13, s71, 0
    s_mov_b32 s14, 8
    s_mov_b32 s15, 0x20000
    buffer_load_dword v254, v249, s[12:15], 0 offen sc1
RS_SKIP:
    ds_read_b128 v[40:43], v3 offset:0
    ds_read_b128 v[44:47], v3 offset:1024
    ds_read_b128 v[48:51], v3 offset:2048
    ds_read_b128 v[52:55], v3 offset:3072
    ds_read_b128 v[56:59], v3 offset:4096
    ds_read_b128 v[60:63], v3 offset:5120
    ds_read_b128 v[64:67], v3 offset:6144
    ds_read_b128 v[68:71], v3 offset:7168
    ds_read_b128 v[72:75], v3 offset:8192
    ds_read_b128 v[76:79], v3 offset:9216
    ds_read_b128 v[80:83], v3 offset:10240
    ds_read_b128 v[84:87], v3 offset:11264
    v_lshrrev_b32 v1, 4, v0
    v_and_b32 v2, 15, v0
    v_and_b32 v3, 4, v2
    v_lshlrev_b32 v3, 1, v3
    v_xor_b32 v3, v2, v3
    v_lshlrev_b32 v31, 2, v1
    v_xor_b32 v31, v31, v3
    v_lshlrev_b32 v31, 4, v31
    v_lshl_add_u32 v10, v2, 8, v31
    v_add_u32 v10, s27, v10
    v_xor_b32 v11, 16, v10
    v_xor_b32 v12, 32, v10
    v_xor_b32 v13, 48, v10
    v_lshrrev_b32 v3, 2, v2
    v_lshl_add_u32 v3, v1, 2, v3
    v_and_b32 v31, 7, v3
    v_lshlrev_b32 v31, 5, v31
    v_lshl_add_u32 v31, v3, 8, v31
    v_and_b32 v3, 3, v2
    v_lshl_add_u32 v14, v3, 3, v31
    v_add_u32 v14, s28, v14
    v_xor_b32 v15, 32, v14
    v_xor_b32 v16, 64, v14
    v_xor_b32 v17, 96, v14
    v_xor_b32 v18, 128, v14
    v_xor_b32 v19, 160, v14
    v_xor_b32 v20, 192, v14
    v_xor_b32 v21, 224, v14
    v_mov_b32 v22, 0xff800000
    v_mov_b32 v25, 0
    v_mov_b32 v23, 0xff800000
    v_mov_b32 v26, 0
    v_mov_b32 v24, 0xff800000
    v_mov_b32 v27, 0
    s_waitcnt lgkmcnt(0)
    s_cmp_eq_u32 s23, 1
    s_cbranch_scc1 START_B
START_A:
    s_mov_b32 s26, 10
.p2align 3
LOOP_A:
    s_waitcnt vmcnt(0)
    ds_read_b128 v[220:223], v10 offset:0
    ds_read_b128 v[224:227], v11 offset:0
    ds_read_b128 v[228:231], v12 offset:0
    ds_read_b128 v[232:235], v13 offset:0
    ds_read_b128 v[236:239], v10 offset:4096
    ds_read_b128 v[240:243], v11 offset:4096
    ds_read_b128 v[244:247], v12 offset:4096
    ds_read_b128 v[248:251], v13 offset:4096
    s_waitcnt lgkmcnt(0)
    s_mov_b32 m0, s28
    s_add_u32 s34, s25, 0x1000
    buffer_load_dwordx4 v8, s[8:11], s25 offen offset:0 lds
    v_mfma_f32_16x16x32_bf16 v[184:187], v[220:223], v[40:43], 0
    v_mfma_f32_16x16x32_bf16 v[196:199], v[236:239], v[40:43], 0
    v_mfma_f32_16x16x32_bf16 v[188:191], v[220:223], v[56:59], 0
    buffer_load_dwordx4 v9, s[8:11], s25 offen offset:1024 lds
    v_mfma_f32_16x16x32_bf16 v[200:203], v[236:239], v[56:59], 0
    v_mfma_f32_16x16x32_bf16 v[192:195], v[220:223], v[72:75], 0
    v_mfma_f32_16x16x32_bf16 v[204:207], v[236:239], v[72:75], 0
    buffer_load_dwordx4 v8, s[8:11], s25 offen offset:2048 lds
    v_mfma_f32_16x16x32_bf16 v[184:187], v[224:227], v[44:47], v[184:187]
    v_mfma_f32_16x16x32_bf16 v[196:199], v[240:243], v[44:47], v[196:199]
    v_mfma_f32_16x16x32_bf16 v[188:191], v[224:227], v[60:63], v[188:191]
    buffer_load_dwordx4 v9, s[8:11], s25 offen offset:3072 lds
    v_mfma_f32_16x16x32_bf16 v[200:203], v[240:243], v[60:63], v[200:203]
    v_mfma_f32_16x16x32_bf16 v[192:195], v[224:227], v[76:79], v[192:195]
    v_mfma_f32_16x16x32_bf16 v[204:207], v[240:243], v[76:79], v[204:207]
    s_add_u32 m0, s28, 0x1000
    s_nop 0
    buffer_load_dwordx4 v8, s[8:11], s34 offen offset:0 lds
    v_mfma_f32_16x16x32_bf16 v[184:187], v[228:231], v[48:51], v[184:187]
    v_mfma_f32_16x16x32_bf16 v[196:199], v[244:247], v[48:51], v[196:199]
    v_mfma_f32_16x16x32_bf16 v[188:191], v[228:231], v[64:67], v[188:191]
    buffer_load_dwordx4 v9, s[8:11], s34 offen offset:1024 lds
    v_mfma_f32_16x16x32_bf16 v[200:203], v[244:247], v[64:67], v[200:203]
    v_mfma_f32_16x16x32_bf16 v[192:195], v[228:231], v[80:83], v[192:195]
    v_mfma_f32_16x16x32_bf16 v[204:207], v[244:247], v[80:83], v[204:207]
    buffer_load_dwordx4 v8, s[8:11], s34 offen offset:2048 lds
    v_mfma_f32_16x16x32_bf16 v[184:187], v[232:235], v[52:55], v[184:187]
    v_mfma_f32_16x16x32_bf16 v[196:199], v[248:251], v[52:55], v[196:199]
    v_mfma_f32_16x16x32_bf16 v[188:191], v[232:235], v[68:71], v[188:191]
    buffer_load_dwordx4 v9, s[8:11], s34 offen offset:3072 lds
    v_mfma_f32_16x16x32_bf16 v[200:203], v[248:251], v[68:71], v[200:203]
    v_mfma_f32_16x16x32_bf16 v[192:195], v[232:235], v[84:87], v[192:195]
    v_mfma_f32_16x16x32_bf16 v[204:207], v[248:251], v[84:87], v[204:207]
    s_add_u32 s97, s97, 1
    s_add_u32 s25, s97, s98
    s_and_b32 s25, s25, 3
    s_and_b32 s34, s97, 12
    s_or_b32 s25, s25, s34
    s_lshl_b32 s25, s25, 15
    s_nop 2
SM_AL:
    v_fma_f32 v32, v184, s30, -v22
    v_fma_f32 v33, v185, s30, -v22
    v_fma_f32 v34, v186, s30, -v22
    v_fma_f32 v35, v187, s30, -v22
    v_fma_f32 v36, v196, s30, -v22
    v_fma_f32 v37, v197, s30, -v22
    v_fma_f32 v38, v198, s30, -v22
    v_fma_f32 v39, v199, s30, -v22
    v_exp_f32 v32, v32
    v_exp_f32 v33, v33
    v_exp_f32 v34, v34
    v_exp_f32 v35, v35
    v_exp_f32 v36, v36
    v_exp_f32 v37, v37
    v_exp_f32 v38, v38
    v_exp_f32 v39, v39
    v_cvt_pk_bf16_f32 v208, v32, v33
    v_cvt_pk_bf16_f32 v209, v34, v35
    v_add_f32 v32, v32, v33
    v_add_f32 v34, v34, v35
    v_cvt_pk_bf16_f32 v210, v36, v37
    v_cvt_pk_bf16_f32 v211, v38, v39
    v_add_f32 v36, v36, v37
    v_add_f32 v38, v38, v39
    v_add_f32 v32, v32, v34
    v_add_f32 v36, v36, v38
    v_add_f32 v28, v32, v36
    v_fma_f32 v32, v188, s30, -v23
    v_fma_f32 v33, v189, s30, -v23
    v_fma_f32 v34, v190, s30, -v23
    v_fma_f32 v35, v191, s30, -v23
    v_fma_f32 v36, v200, s30, -v23
    v_fma_f32 v37, v201, s30, -v23
    v_fma_f32 v38, v202, s30, -v23
    v_fma_f32 v39, v203, s30, -v23
    v_exp_f32 v32, v32
    v_exp_f32 v33, v33
    v_exp_f32 v34, v34
    v_exp_f32 v35, v35
    v_exp_f32 v36, v36
    v_exp_f32 v37, v37
    v_exp_f32 v38, v38
    v_exp_f32 v39, v39
    v_cvt_pk_bf16_f32 v212, v32, v33
    v_cvt_pk_bf16_f32 v213, v34, v35
    v_add_f32 v32, v32, v33
    v_add_f32 v34, v34, v35
    v_cvt_pk_bf16_f32 v214, v36, v37
    v_cvt_pk_bf16_f32 v215, v38, v39
    v_add_f32 v36, v36, v37
    v_add_f32 v38, v38, v39
    v_add_f32 v32, v32, v34
    v_add_f32 v36, v36, v38
    v_add_f32 v29, v32, v36
    v_fma_f32 v32, v192, s30, -v24
    v_fma_f32 v33, v193, s30, -v24
    v_fma_f32 v34, v194, s30, -v24
    v_fma_f32 v35, v195, s30, -v24
    v_fma_f32 v36, v204, s30, -v24
    v_fma_f32 v37, v205, s30, -v24
    v_fma_f32 v38, v206, s30, -v24
    v_fma_f32 v39, v207, s30, -v24
    v_exp_f32 v32, v32
    v_exp_f32 v33, v33
    v_exp_f32 v34, v34
    v_exp_f32 v35, v35
    v_exp_f32 v36, v36
    v_exp_f32 v37, v37
    v_exp_f32 v38, v38
    v_exp_f32 v39, v39
    v_cvt_pk_bf16_f32 v216, v32, v33
    v_cvt_pk_bf16_f32 v217, v34, v35
    v_add_f32 v32, v32, v33
    v_add_f32 v34, v34, v35
    v_cvt_pk_bf16_f32 v218, v36, v37
    v_cvt_pk_bf16_f32 v219, v38, v39
    v_add_f32 v36, v36, v37
    v_add_f32 v38, v38, v39
    v_add_f32 v32, v32, v34
    v_add_f32 v36, v36, v38
    v_add_f32 v30, v32, v36
    v_max3_f32 v31, v28, v29, v30
    v_cmp_lt_f32 vcc, s31, v31
    s_cbranch_vccnz SLOW_AL
    s_mov_b32 s31, 0x43800000
    v_add_f32 v25, v25, v28
    v_add_f32 v26, v26, v29
    v_add_f32 v27, v27, v30
    s_waitcnt vmcnt(0)
    ds_read_b64_tr_b16 v[220:221], v14
    ds_read_b64_tr_b16 v[222:223], v14 offset:4096
    ds_read_b64_tr_b16 v[224:225], v15
    ds_read_b64_tr_b16 v[226:227], v15 offset:4096
    ds_read_b64_tr_b16 v[228:229], v16
    ds_read_b64_tr_b16 v[230:231], v16 offset:4096
    ds_read_b64_tr_b16 v[232:233], v17
    ds_read_b64_tr_b16 v[234:235], v17 offset:4096
    ds_read_b64_tr_b16 v[236:237], v18
    ds_read_b64_tr_b16 v[238:239], v18 offset:4096
    ds_read_b64_tr_b16 v[240:241], v19
    ds_read_b64_tr_b16 v[242:243], v19 offset:4096
    ds_read_b64_tr_b16 v[244:245], v20
    ds_read_b64_tr_b16 v[246:247], v20 offset:4096
    ds_read_b64_tr_b16 v[248:249], v21
    ds_read_b64_tr_b16 v[250:251], v21 offset:4096
    s_waitcnt lgkmcnt(0)
    s_mov_b32 m0, s27
    s_add_u32 s34, s24, 0x1000
    buffer_load_dwordx4 v4, s[4:7], s24 offen offset:0 lds
    v_mfma_f32_16x16x32_bf16 v[88:91], v[220:223], v[208:211], v[88:91]
    v_mfma_f32_16x16x32_bf16 v[92:95], v[220:223], v[212:215], v[92:95]
    v_mfma_f32_16x16x32_bf16 v[96:99], v[220:223], v[216:219], v[96:99]
    buffer_load_dwordx4 v5, s[4:7], s24 offen offset:1024 lds
    v_mfma_f32_16x16x32_bf16 v[100:103], v[224:227], v[208:211], v[100:103]
    v_mfma_f32_16x16x32_bf16 v[104:107], v[224:227], v[212:215], v[104:107]
    v_mfma_f32_16x16x32_bf16 v[108:111], v[224:227], v[216:219], v[108:111]
    buffer_load_dwordx4 v6, s[4:7], s24 offen offset:2048 lds
    v_mfma_f32_16x16x32_bf16 v[112:115], v[228:231], v[208:211], v[112:115]
    v_mfma_f32_16x16x32_bf16 v[116:119], v[228:231], v[212:215], v[116:119]
    v_mfma_f32_16x16x32_bf16 v[120:123], v[228:231], v[216:219], v[120:123]
    buffer_load_dwordx4 v7, s[4:7], s24 offen offset:3072 lds
    v_mfma_f32_16x16x32_bf16 v[124:127], v[232:235], v[208:211], v[124:127]
    v_mfma_f32_16x16x32_bf16 v[128:131], v[232:235], v[212:215], v[128:131]
    v_mfma_f32_16x16x32_bf16 v[132:135], v[232:235], v[216:219], v[132:135]
    s_add_u32 m0, s27, 0x1000
    s_nop 0
    buffer_load_dwordx4 v4, s[4:7], s34 offen offset:0 lds
    v_mfma_f32_16x16x32_bf16 v[136:139], v[236:239], v[208:211], v[136:139]
    v_mfma_f32_16x16x32_bf16 v[140:143], v[236:239], v[212:215], v[140:143]
    v_mfma_f32_16x16x32_bf16 v[144:147], v[236:239], v[216:219], v[144:147]
    buffer_load_dwordx4 v5, s[4:7], s34 offen offset:1024 lds
    v_mfma_f32_16x16x32_bf16 v[148:151], v[240:243], v[208:211], v[148:151]
    v_mfma_f32_16x16x32_bf16 v[152:155], v[240:243], v[212:215], v[152:155]
    v_mfma_f32_16x16x32_bf16 v[156:159], v[240:243], v[216:219], v[156:159]
    buffer_load_dwordx4 v6, s[4:7], s34 offen offset:2048 lds
    v_mfma_f32_16x16x32_bf16 v[160:163], v[244:247], v[208:211], v[160:163]
    v_mfma_f32_16x16x32_bf16 v[164:167], v[244:247], v[212:215], v[164:167]
    v_mfma_f32_16x16x32_bf16 v[168:171], v[244:247], v[216:219], v[168:171]
    buffer_load_dwordx4 v7, s[4:7], s34 offen offset:3072 lds
    v_mfma_f32_16x16x32_bf16 v[172:175], v[248:251], v[208:211], v[172:175]
    v_mfma_f32_16x16x32_bf16 v[176:179], v[248:251], v[212:215], v[176:179]
    v_mfma_f32_16x16x32_bf16 v[180:183], v[248:251], v[216:219], v[180:183]
    s_add_u32 s96, s96, 1
    s_add_u32 s24, s96, s98
    s_and_b32 s24, s24, 3
    s_and_b32 s34, s96, 12
    s_or_b32 s24, s24, s34
    s_lshl_b32 s24, s24, 15
    s_sub_u32 s26, s26, 1
    s_cmp_lg_u32 s26, 0
    s_cbranch_scc1 LOOP_A
    s_waitcnt vmcnt(0)
    ds_read_b128 v[220:223], v10 offset:0
    ds_read_b128 v[224:227], v11 offset:0
    ds_read_b128 v[228:231], v12 offset:0
    ds_read_b128 v[232:235], v13 offset:0
    ds_read_b128 v[236:239], v10 offset:4096
    ds_read_b128 v[240:243], v11 offset:4096
    ds_read_b128 v[244:247], v12 offset:4096
    ds_read_b128 v[248:251], v13 offset:4096
    s_waitcnt lgkmcnt(0)
    s_mov_b32 m0, s28
    s_add_u32 s34, s25, 0x1000
    buffer_load_dwordx4 v8, s[8:11], s25 offen offset:0 lds
    v_mfma_f32_16x16x32_bf16 v[184:187], v[220:223], v[40:43], 0
    v_mfma_f32_16x16x32_bf16 v[196:199], v[236:239], v[40:43], 0
    v_mfma_f32_16x16x32_bf16 v[188:191], v[220:223], v[56:59], 0
    buffer_load_dwordx4 v9, s[8:11], s25 offen offset:1024 lds
    v_mfma_f32_16x16x32_bf16 v[200:203], v[236:239], v[56:59], 0
    v_mfma_f32_16x16x32_bf16 v[192:195], v[220:223], v[72:75], 0
    v_mfma_f32_16x16x32_bf16 v[204:207], v[236:239], v[72:75], 0
    buffer_load_dwordx4 v8, s[8:11], s25 offen offset:2048 lds
    v_mfma_f32_16x16x32_bf16 v[184:187], v[224:227], v[44:47], v[184:187]
    v_mfma_f32_16x16x32_bf16 v[196:199], v[240:243], v[44:47], v[196:199]
    v_mfma_f32_16x16x32_bf16 v[188:191], v[224:227], v[60:63], v[188:191]
    buffer_load_dwordx4 v9, s[8:11], s25 offen offset:3072 lds
    v_mfma_f32_16x16x32_bf16 v[200:203], v[240:243], v[60:63], v[200:203]
    v_mfma_f32_16x16x32_bf16 v[192:195], v[224:227], v[76:79], v[192:195]
    v_mfma_f32_16x16x32_bf16 v[204:207], v[240:243], v[76:79], v[204:207]
    s_add_u32 m0, s28, 0x1000
    s_nop 0
    buffer_load_dwordx4 v8, s[8:11], s34 offen offset:0 lds
    v_mfma_f32_16x16x32_bf16 v[184:187], v[228:231], v[48:51], v[184:187]
    v_mfma_f32_16x16x32_bf16 v[196:199], v[244:247], v[48:51], v[196:199]
    v_mfma_f32_16x16x32_bf16 v[188:191], v[228:231], v[64:67], v[188:191]
    buffer_load_dwordx4 v9, s[8:11], s34 offen offset:1024 lds
    v_mfma_f32_16x16x32_bf16 v[200:203], v[244:247], v[64:67], v[200:203]
    v_mfma_f32_16x16x32_bf16 v[192:195], v[228:231], v[80:83], v[192:195]
    v_mfma_f32_16x16x32_bf16 v[204:207], v[244:247], v[80:83], v[204:207]
    buffer_load_dwordx4 v8, s[8:11], s34 offen offset:2048 lds
    v_mfma_f32_16x16x32_bf16 v[184:187], v[232:235], v[52:55], v[184:187]
    v_mfma_f32_16x16x32_bf16 v[196:199], v[248:251], v[52:55], v[196:199]
    v_mfma_f32_16x16x32_bf16 v[188:191], v[232:235], v[68:71], v[188:191]
    buffer_load_dwordx4 v9, s[8:11], s34 offen offset:3072 lds
    v_mfma_f32_16x16x32_bf16 v[200:203], v[248:251], v[68:71], v[200:203]
    v_mfma_f32_16x16x32_bf16 v[192:195], v[232:235], v[84:87], v[192:195]
    v_mfma_f32_16x16x32_bf16 v[204:207], v[248:251], v[84:87], v[204:207]
    s_add_u32 s97, s97, 1
    s_add_u32 s25, s97, s98
    s_and_b32 s25, s25, 3
    s_and_b32 s34, s97, 12
    s_or_b32 s25, s25, s34
    s_lshl_b32 s25, s25, 15
    s_mov_b32 m0, s27
    s_add_u32 s34, s24, 0x1000
    buffer_load_dwordx4 v4, s[4:7], s24 offen offset:0 lds
    buffer_load_dwordx4 v5, s[4:7], s24 offen offset:1024 lds
    buffer_load_dwordx4 v6, s[4:7], s24 offen offset:2048 lds
    buffer_load_dwordx4 v7, s[4:7], s24 offen offset:3072 lds
    s_add_u32 m0, s27, 0x1000
    s_nop 0
    buffer_load_dwordx4 v4, s[4:7], s34 offen offset:0 lds
    buffer_load_dwordx4 v5, s[4:7], s34 offen offset:1024 lds
    buffer_load_dwordx4 v6, s[4:7], s34 offen offset:2048 lds
    buffer_load_dwordx4 v7, s[4:7], s34 offen offset:3072 lds
    s_add_u32 s96, s96, 1
    s_add_u32 s24, s96, s98
    s_and_b32 s24, s24, 3
    s_and_b32 s34, s96, 12
    s_or_b32 s24, s24, s34
    s_lshl_b32 s24, s24, 15
    s_nop 2
SM_AU:
    v_fma_f32 v32, v184, s30, -v22
    v_fma_f32 v33, v185, s30, -v22
    v_fma_f32 v34, v186, s30, -v22
    v_fma_f32 v35, v187, s30, -v22
    v_fma_f32 v36, v196, s30, -v22
    v_fma_f32 v37, v197, s30, -v22
    v_fma_f32 v38, v198, s30, -v22
    v_fma_f32 v39, v199, s30, -v22
    v_exp_f32 v32, v32
    v_exp_f32 v33, v33
    v_exp_f32 v34, v34
    v_exp_f32 v35, v35
    v_exp_f32 v36, v36
    v_exp_f32 v37, v37
    v_exp_f32 v38, v38
    v_exp_f32 v39, v39
    v_cvt_pk_bf16_f32 v208, v32, v33
    v_cvt_pk_bf16_f32 v209, v34, v35
    v_add_f32 v32, v32, v33
    v_add_f32 v34, v34, v35
    v_cvt_pk_bf16_f32 v210, v36, v37
    v_cvt_pk_bf16_f32 v211, v38, v39
    v_add_f32 v36, v36, v37
    v_add_f32 v38, v38, v39
    v_add_f32 v32, v32, v34
    v_add_f32 v36, v36, v38
    v_add_f32 v28, v32, v36
    v_fma_f32 v32, v188, s30, -v23
    v_fma_f32 v33, v189, s30, -v23
    v_fma_f32 v34, v190, s30, -v23
    v_fma_f32 v35, v191, s30, -v23
    v_fma_f32 v36, v200, s30, -v23
    v_fma_f32 v37, v201, s30, -v23
    v_fma_f32 v38, v202, s30, -v23
    v_fma_f32 v39, v203, s30, -v23
    v_exp_f32 v32, v32
    v_exp_f32 v33, v33
    v_exp_f32 v34, v34
    v_exp_f32 v35, v35
    v_exp_f32 v36, v36
    v_exp_f32 v37, v37
    v_exp_f32 v38, v38
    v_exp_f32 v39, v39
    v_cvt_pk_bf16_f32 v212, v32, v33
    v_cvt_pk_bf16_f32 v213, v34, v35
    v_add_f32 v32, v32, v33
    v_add_f32 v34, v34, v35
    v_cvt_pk_bf16_f32 v214, v36, v37
    v_cvt_pk_bf16_f32 v215, v38, v39
    v_add_f32 v36, v36, v37
    v_add_f32 v38, v38, v39
    v_add_f32 v32, v32, v34
    v_add_f32 v36, v36, v38
    v_add_f32 v29, v32, v36
    v_fma_f32 v32, v192, s30, -v24
    v_fma_f32 v33, v193, s30, -v24
    v_fma_f32 v34, v194, s30, -v24
    v_fma_f32 v35, v195, s30, -v24
    v_fma_f32 v36, v204, s30, -v24
    v_fma_f32 v37, v205, s30, -v24
    v_fma_f32 v38, v206, s30, -v24
    v_fma_f32 v39, v207, s30, -v24
    v_exp_f32 v32, v32
    v_exp_f32 v33, v33
    v_exp_f32 v34, v34
    v_exp_f32 v35, v35
    v_exp_f32 v36, v36
    v_exp_f32 v37, v37
    v_exp_f32 v38, v38
    v_exp_f32 v39, v39
    v_cvt_pk_bf16_f32 v216, v32, v33
    v_cvt_pk_bf16_f32 v217, v34, v35
    v_add_f32 v32, v32, v33
    v_add_f32 v34, v34, v35
    v_cvt_pk_bf16_f32 v218, v36, v37
    v_cvt_pk_bf16_f32 v219, v38, v39
    v_add_f32 v36, v36, v37
    v_add_f32 v38, v38, v39
    v_add_f32 v32, v32, v34
    v_add_f32 v36, v36, v38
    v_add_f32 v30, v32, v36
    v_max3_f32 v31, v28, v29, v30
    v_cmp_lt_f32 vcc, s31, v31
    s_cbranch_vccnz SLOW_AU
    s_mov_b32 s31, 0x43800000
    v_add_f32 v25, v25, v28
    v_add_f32 v26, v26, v29
    v_add_f32 v27, v27, v30
    s_waitcnt vmcnt(8)
    ds_read_b64_tr_b16 v[220:221], v14
    ds_read_b64_tr_b16 v[222:223], v14 offset:4096
    ds_read_b64_tr_b16 v[224:225], v15
    ds_read_b64_tr_b16 v[226:227], v15 offset:4096
    ds_read_b64_tr_b16 v[228:229], v16
    ds_read_b64_tr_b16 v[230:231], v16 offset:4096
    ds_read_b64_tr_b16 v[232:233], v17
    ds_read_b64_tr_b16 v[234:235], v17 offset:4096
    ds_read_b64_tr_b16 v[236:237], v18
    ds_read_b64_tr_b16 v[238:239], v18 offset:4096
    ds_read_b64_tr_b16 v[240:241], v19
    ds_read_b64_tr_b16 v[242:243], v19 offset:4096
    ds_read_b64_tr_b16 v[244:245], v20
    ds_read_b64_tr_b16 v[246:247], v20 offset:4096
    ds_read_b64_tr_b16 v[248:249], v21
    ds_read_b64_tr_b16 v[250:251], v21 offset:4096
    s_waitcnt lgkmcnt(0)
    s_mov_b32 m0, s28
    s_add_u32 s34, s25, 0x1000
    buffer_load_dwordx4 v8, s[8:11], s25 offen offset:0 lds
    v_mfma_f32_16x16x32_bf16 v[88:91], v[220:223], v[208:211], v[88:91]
    v_mfma_f32_16x16x32_bf16 v[92:95], v[220:223], v[212:215], v[92:95]
    v_mfma_f32_16x16x32_bf16 v[96:99], v[220:223], v[216:219], v[96:99]
    buffer_load_dwordx4 v9, s[8:11], s25 offen offset:1024 lds
    v_mfma_f32_16x16x32_bf16 v[100:103], v[224:227], v[208:211], v[100:103]
    v_mfma_f32_16x16x32_bf16 v[104:107], v[224:227], v[212:215], v[104:107]
    v_mfma_f32_16x16x32_bf16 v[108:111], v[224:227], v[216:219], v[108:111]
    buffer_load_dwordx4 v8, s[8:11], s25 offen offset:2048 lds
    v_mfma_f32_16x16x32_bf16 v[112:115], v[228:231], v[208:211], v[112:115]
    v_mfma_f32_16x16x32_bf16 v[116:119], v[228:231], v[212:215], v[116:119]
    v_mfma_f32_16x16x32_bf16 v[120:123], v[228:231], v[216:219], v[120:123]
    buffer_load_dwordx4 v9, s[8:11], s25 offen offset:3072 lds
    v_mfma_f32_16x16x32_bf16 v[124:127], v[232:235], v[208:211], v[124:127]
    v_mfma_f32_16x16x32_bf16 v[128:131], v[232:235], v[212:215], v[128:131]
    v_mfma_f32_16x16x32_bf16 v[132:135], v[232:235], v[216:219], v[132:135]
    s_add_u32 m0, s28, 0x1000
    s_nop 0
    buffer_load_dwordx4 v8, s[8:11], s34 offen offset:0 lds
    v_mfma_f32_16x16x32_bf16 v[136:139], v[236:239], v[208:211], v[136:139]
    v_mfma_f32_16x16x32_bf16 v[140:143], v[236:239], v[212:215], v[140:143]
    v_mfma_f32_16x16x32_bf16 v[144:147], v[236:239], v[216:219], v[144:147]
    buffer_load_dwordx4 v9, s[8:11], s34 offen offset:1024 lds
    v_mfma_f32_16x16x32_bf16 v[148:151], v[240:243], v[208:211], v[148:151]
    v_mfma_f32_16x16x32_bf16 v[152:155], v[240:243], v[212:215], v[152:155]
    v_mfma_f32_16x16x32_bf16 v[156:159], v[240:243], v[216:219], v[156:159]
    buffer_load_dwordx4 v8, s[8:11], s34 offen offset:2048 lds
    v_mfma_f32_16x16x32_bf16 v[160:163], v[244:247], v[208:211], v[160:163]
    v_mfma_f32_16x16x32_bf16 v[164:167], v[244:247], v[212:215], v[164:167]
    v_mfma_f32_16x16x32_bf16 v[168:171], v[244:247], v[216:219], v[168:171]
    buffer_load_dwordx4 v9, s[8:11], s34 offen offset:3072 lds
    v_mfma_f32_16x16x32_bf16 v[172:175], v[248:251], v[208:211], v[172:175]
    v_mfma_f32_16x16x32_bf16 v[176:179], v[248:251], v[212:215], v[176:179]
    v_mfma_f32_16x16x32_bf16 v[180:183], v[248:251], v[216:219], v[180:183]
    s_add_u32 s97, s97, 1
    s_add_u32 s25, s97, s98
    s_and_b32 s25, s25, 3
    s_and_b32 s34, s97, 12
    s_or_b32 s25, s25, s34
    s_lshl_b32 s25, s25, 15
    s_mov_b32 s26, 4
.p2align 3
LOOP2_A:
    s_waitcnt vmcnt(8)
    ds_read_b128 v[220:223], v10 offset:0
    ds_read_b128 v[224:227], v11 offset:0
    ds_read_b128 v[228:231], v12 offset:0
    ds_read_b128 v[232:235], v13 offset:0
    ds_read_b128 v[236:239], v10 offset:4096
    ds_read_b128 v[240:243], v11 offset:4096
    ds_read_b128 v[244:247], v12 offset:4096
    ds_read_b128 v[248:251], v13 offset:4096
    s_waitcnt lgkmcnt(0)
    s_mov_b32 m0, s27
    s_add_u32 s34, s24, 0x1000
    buffer_load_dwordx4 v4, s[4:7], s24 offen offset:0 lds
    v_mfma_f32_16x16x32_bf16 v[184:187], v[220:223], v[40:43], 0
    v_mfma_f32_16x16x32_bf16 v[196:199], v[236:239], v[40:43], 0
    v_mfma_f32_16x16x32_bf16 v[188:191], v[220:223], v[56:59], 0
    buffer_load_dwordx4 v5, s[4:7], s24 offen offset:1024 lds
    v_mfma_f32_16x16x32_bf16 v[200:203], v[236:239], v[56:59], 0
    v_mfma_f32_16x16x32_bf16 v[192:195], v[220:223], v[72:75], 0
    v_mfma_f32_16x16x32_bf16 v[204:207], v[236:239], v[72:75], 0
    buffer_load_dwordx4 v6, s[4:7], s24 offen offset:2048 lds
    v_mfma_f32_16x16x32_bf16 v[184:187], v[224:227], v[44:47], v[184:187]
    v_mfma_f32_16x16x32_bf16 v[196:199], v[240:243], v[44:47], v[196:199]
    v_mfma_f32_16x16x32_bf16 v[188:191], v[224:227], v[60:63], v[188:191]
    buffer_load_dwordx4 v7, s[4:7], s24 offen offset:3072 lds
    v_mfma_f32_16x16x32_bf16 v[200:203], v[240:243], v[60:63], v[200:203]
    v_mfma_f32_16x16x32_bf16 v[192:195], v[224:227], v[76:79], v[192:195]
    v_mfma_f32_16x16x32_bf16 v[204:207], v[240:243], v[76:79], v[204:207]
    s_add_u32 m0, s27, 0x1000
    s_nop 0
    buffer_load_dwordx4 v4, s[4:7], s34 offen offset:0 lds
    v_mfma_f32_16x16x32_bf16 v[184:187], v[228:231], v[48:51], v[184:187]
    v_mfma_f32_16x16x32_bf16 v[196:199], v[244:247], v[48:51], v[196:199]
    v_mfma_f32_16x16x32_bf16 v[188:191], v[228:231], v[64:67], v[188:191]
    buffer_load_dwordx4 v5, s[4:7], s34 offen offset:1024 lds
    v_mfma_f32_16x16x32_bf16 v[200:203], v[244:247], v[64:67], v[200:203]
    v_mfma_f32_16x16x32_bf16 v[192:195], v[228:231], v[80:83], v[192:195]
    v_mfma_f32_16x16x32_bf16 v[204:207], v[244:247], v[80:83], v[204:207]
    buffer_load_dwordx4 v6, s[4:7], s34 offen offset:2048 lds
    v_mfma_f32_16x16x32_bf16 v[184:187], v[232:235], v[52:55], v[184:187]
    v_mfma_f32_16x16x32_bf16 v[196:199], v[248:251], v[52:55], v[196:199]
    v_mfma_f32_16x16x32_bf16 v[188:191], v[232:235], v[68:71], v[188:191]
    buffer_load_dwordx4 v7, s[4:7], s34 offen offset:3072 lds
    v_mfma_f32_16x16x32_bf16 v[200:203], v[248:251], v[68:71], v[200:203]
    v_mfma_f32_16x16x32_bf16 v[192:195], v[232:235], v[84:87], v[192:195]
    v_mfma_f32_16x16x32_bf16 v[204:207], v[248:251], v[84:87], v[204:207]
    s_add_u32 s96, s96, 1
    s_add_u32 s24, s96, s98
    s_and_b32 s24, s24, 3
    s_and_b32 s34, s96, 12
    s_or_b32 s24, s24, s34
    s_lshl_b32 s24, s24, 15
    s_nop 2
SM_A2:
    v_fma_f32 v32, v184, s30, -v22
    v_fma_f32 v33, v185, s30, -v22
    v_fma_f32 v34, v186, s30, -v22
    v_fma_f32 v35, v187, s30, -v22
    v_fma_f32 v36, v196, s30, -v22
    v_fma_f32 v37, v197, s30, -v22
    v_fma_f32 v38, v198, s30, -v22
    v_fma_f32 v39, v199, s30, -v22
    v_exp_f32 v32, v32
    v_exp_f32 v33, v33
    v_exp_f32 v34, v34
    v_exp_f32 v35, v35
    v_exp_f32 v36, v36
    v_exp_f32 v37, v37
    v_exp_f32 v38, v38
    v_exp_f32 v39, v39
    v_cvt_pk_bf16_f32 v208, v32, v33
    v_cvt_pk_bf16_f32 v209, v34, v35
    v_add_f32 v32, v32, v33
    v_add_f32 v34, v34, v35
    v_cvt_pk_bf16_f32 v210, v36, v37
    v_cvt_pk_bf16_f32 v211, v38, v39
    v_add_f32 v36, v36, v37
    v_add_f32 v38, v38, v39
    v_add_f32 v32, v32, v34
    v_add_f32 v36, v36, v38
    v_add_f32 v28, v32, v36
    v_fma_f32 v32, v188, s30, -v23
    v_fma_f32 v33, v189, s30, -v23
    v_fma_f32 v34, v190, s30, -v23
    v_fma_f32 v35, v191, s30, -v23
    v_fma_f32 v36, v200, s30, -v23
    v_fma_f32 v37, v201, s30, -v23
    v_fma_f32 v38, v202, s30, -v23
    v_fma_f32 v39, v203, s30, -v23
    v_exp_f32 v32, v32
    v_exp_f32 v33, v33
    v_exp_f32 v34, v34
    v_exp_f32 v35, v35
    v_exp_f32 v36, v36
    v_exp_f32 v37, v37
    v_exp_f32 v38, v38
    v_exp_f32 v39, v39
    v_cvt_pk_bf16_f32 v212, v32, v33
    v_cvt_pk_bf16_f32 v213, v34, v35
    v_add_f32 v32, v32, v33
    v_add_f32 v34, v34, v35
    v_cvt_pk_bf16_f32 v214, v36, v37
    v_cvt_pk_bf16_f32 v215, v38, v39
    v_add_f32 v36, v36, v37
    v_add_f32 v38, v38, v39
    v_add_f32 v32, v32, v34
    v_add_f32 v36, v36, v38
    v_add_f32 v29, v32, v36
    v_fma_f32 v32, v192, s30, -v24
    v_fma_f32 v33, v193, s30, -v24
    v_fma_f32 v34, v194, s30, -v24
    v_fma_f32 v35, v195, s30, -v24
    v_fma_f32 v36, v204, s30, -v24
    v_fma_f32 v37, v205, s30, -v24
    v_fma_f32 v38, v206, s30, -v24
    v_fma_f32 v39, v207, s30, -v24
    v_exp_f32 v32, v32
    v_exp_f32 v33, v33
    v_exp_f32 v34, v34
    v_exp_f32 v35, v35
    v_exp_f32 v36, v36
    v_exp_f32 v37, v37
    v_exp_f32 v38, v38
    v_exp_f32 v39, v39
    v_cvt_pk_bf16_f32 v216, v32, v33
    v_cvt_pk_bf16_f32 v217, v34, v35
    v_add_f32 v32, v32, v33
    v_add_f32 v34, v34, v35
    v_cvt_pk_bf16_f32 v218, v36, v37
    v_cvt_pk_bf16_f32 v219, v38, v39
    v_add_f32 v36, v36, v37
    v_add_f32 v38, v38, v39
    v_add_f32 v32, v32, v34
    v_add_f32 v36, v36, v38
    v_add_f32 v30, v32, v36
    v_max3_f32 v31, v28, v29, v30
    v_cmp_lt_f32 vcc, s31, v31
    s_cbranch_vccnz SLOW_A2
    s_mov_b32 s31, 0x43800000
    v_add_f32 v25, v25, v28
    v_add_f32 v26, v26, v29
    v_add_f32 v27, v27, v30
    s_waitcnt vmcnt(8)
    ds_read_b64_tr_b16 v[220:221], v14
    ds_read_b64_tr_b16 v[222:223], v14 offset:4096
    ds_read_b64_tr_b16 v[224:225], v15
    ds_read_b64_tr_b16 v[226:227], v15 offset:4096
    ds_read_b64_tr_b16 v[228:229], v16
    ds_read_b64_tr_b16 v[230:231], v16 offset:4096
    ds_read_b64_tr_b16 v[232:233], v17
    ds_read_b64_tr_b16 v[234:235], v17 offset:4096
    ds_read_b64_tr_b16 v[236:237], v18
    ds_read_b64_tr_b16 v[238:239], v18 offset:4096
    ds_read_b64_tr_b16 v[240:241], v19
    ds_read_b64_tr_b16 v[242:243], v19 offset:4096
    ds_read_b64_tr_b16 v[244:245], v20
    ds_read_b64_tr_b16 v[246:247], v20 offset:4096
    ds_read_b64_tr_b16 v[248:249], v21
    ds_read_b64_tr_b16 v[250:251], v21 offset:4096
    s_waitcnt lgkmcnt(0)
    s_mov_b32 m0, s28
    s_add_u32 s34, s25, 0x1000
    buffer_load_dwordx4 v8, s[8:11], s25 offen offset:0 lds
    v_mfma_f32_16x16x32_bf16 v[88:91], v[220:223], v[208:211], v[88:91]
    v_mfma_f32_16x16x32_bf16 v[92:95], v[220:223], v[212:215], v[92:95]
    v_mfma_f32_16x16x32_bf16 v[96:99], v[220:223], v[216:219], v[96:99]
    buffer_load_dwordx4 v9, s[8:11], s25 offen offset:1024 lds
    v_mfma_f32_16x16x32_bf16 v[100:103], v[224:227], v[208:211], v[100:103]
    v_mfma_f32_16x16x32_bf16 v[104:107], v[224:227], v[212:215], v[104:107]
    v_mfma_f32_16x16x32_bf16 v[108:111], v[224:227], v[216:219], v[108:111]
    buffer_load_dwordx4 v8, s[8:11], s25 offen offset:2048 lds
    v_mfma_f32_16x16x32_bf16 v[112:115], v[228:231], v[208:211], v[112:115]
    v_mfma_f32_16x16x32_bf16 v[116:119], v[228:231], v[212:215], v[116:119]
    v_mfma_f32_16x16x32_bf16 v[120:123], v[228:231], v[216:219], v[120:123]
    buffer_load_dwordx4 v9, s[8:11], s25 offen offset:3072 lds
    v_mfma_f32_16x16x32_bf16 v[124:127], v[232:235], v[208:211], v[124:127]
    v_mfma_f32_16x16x32_bf16 v[128:131], v[232:235], v[212:215], v[128:131]
    v_mfma_f32_16x16x32_bf16 v[132:135], v[232:235], v[216:219], v[132:135]
    s_add_u32 m0, s28, 0x1000
    s_nop 0
    buffer_load_dwordx4 v8, s[8:11], s34 offen offset:0 lds
    v_mfma_f32_16x16x32_bf16 v[136:139], v[236:239], v[208:211], v[136:139]
    v_mfma_f32_16x16x32_bf16 v[140:143], v[236:239], v[212:215], v[140:143]
    v_mfma_f32_16x16x32_bf16 v[144:147], v[236:239], v[216:219], v[144:147]
    buffer_load_dwordx4 v9, s[8:11], s34 offen offset:1024 lds
    v_mfma_f32_16x16x32_bf16 v[148:151], v[240:243], v[208:211], v[148:151]
    v_mfma_f32_16x16x32_bf16 v[152:155], v[240:243], v[212:215], v[152:155]
    v_mfma_f32_16x16x32_bf16 v[156:159], v[240:243], v[216:219], v[156:159]
    buffer_load_dwordx4 v8, s[8:11], s34 offen offset:2048 lds
    v_mfma_f32_16x16x32_bf16 v[160:163], v[244:247], v[208:211], v[160:163]
    v_mfma_f32_16x16x32_bf16 v[164:167], v[244:247], v[212:215], v[164:167]
    v_mfma_f32_16x16x32_bf16 v[168:171], v[244:247], v[216:219], v[168:171]
    buffer_load_dwordx4 v9, s[8:11], s34 offen offset:3072 lds
    v_mfma_f32_16x16x32_bf16 v[172:175], v[248:251], v[208:211], v[172:175]
    v_mfma_f32_16x16x32_bf16 v[176:179], v[248:251], v[212:215], v[176:179]
    v_mfma_f32_16x16x32_bf16 v[180:183], v[248:251], v[216:219], v[180:183]
    s_add_u32 s97, s97, 1
    s_add_u32 s25, s97, s98
    s_and_b32 s25, s25, 3
    s_and_b32 s34, s97, 12
    s_or_b32 s25, s25, s34
    s_lshl_b32 s25, s25, 15
    s_sub_u32 s26, s26, 1
    s_cmp_lg_u32 s26, 0
    s_cbranch_scc1 LOOP2_A
    s_waitcnt vmcnt(8)
    ds_read_b128 v[220:223], v10 offset:0
    ds_read_b128 v[224:227], v11 offset:0
    ds_read_b128 v[228:231], v12 offset:0
    ds_read_b128 v[232:235], v13 offset:0
    ds_read_b128 v[236:239], v10 offset:4096
    ds_read_b128 v[240:243], v11 offset:4096
    ds_read_b128 v[244:247], v12 offset:4096
    ds_read_b128 v[248:251], v13 offset:4096
    s_waitcnt lgkmcnt(0)
    v_mfma_f32_16x16x32_bf16 v[184:187], v[220:223], v[40:43], 0
    v_mfma_f32_16x16x32_bf16 v[196:199], v[236:239], v[40:43], 0
    v_mfma_f32_16x16x32_bf16 v[188:191], v[220:223], v[56:59], 0
    v_mfma_f32_16x16x32_bf16 v[200:203], v[236:239], v[56:59], 0
    v_mfma_f32_16x16x32_bf16 v[192:195], v[220:223], v[72:75], 0
    v_mfma_f32_16x16x32_bf16 v[204:207], v[236:239], v[72:75], 0
    v_mfma_f32_16x16x32_bf16 v[184:187], v[224:227], v[44:47], v[184:187]
    v_mfma_f32_16x16x32_bf16 v[196:199], v[240:243], v[44:47], v[196:199]
    v_mfma_f32_16x16x32_bf16 v[188:191], v[224:227], v[60:63], v[188:191]
    v_mfma_f32_16x16x32_bf16 v[200:203], v[240:243], v[60:63], v[200:203]
    v_mfma_f32_16x16x32_bf16 v[192:195], v[224:227], v[76:79], v[192:195]
    v_mfma_f32_16x16x32_bf16 v[204:207], v[240:243], v[76:79], v[204:207]
    v_mfma_f32_16x16x32_bf16 v[184:187], v[228:231], v[48:51], v[184:187]
    v_mfma_f32_16x16x32_bf16 v[196:199], v[244:247], v[48:51], v[196:199]
    v_mfma_f32_16x16x32_bf16 v[188:191], v[228:231], v[64:67], v[188:191]
    v_mfma_f32_16x16x32_bf16 v[200:203], v[244:247], v[64:67], v[200:203]
    v_mfma_f32_16x16x32_bf16 v[192:195], v[228:231], v[80:83], v[192:195]
    v_mfma_f32_16x16x32_bf16 v[204:207], v[244:247], v[80:83], v[204:207]
    v_mfma_f32_16x16x32_bf16 v[184:187], v[232:235], v[52:55], v[184:187]
    v_mfma_f32_16x16x32_bf16 v[196:199], v[248:251], v[52:55], v[196:199]
    v_mfma_f32_16x16x32_bf16 v[188:191], v[232:235], v[68:71], v[188:191]
    v_mfma_f32_16x16x32_bf16 v[200:203], v[248:251], v[68:71], v[200:203]
    v_mfma_f32_16x16x32_bf16 v[192:195], v[232:235], v[84:87], v[192:195]
    v_mfma_f32_16x16x32_bf16 v[204:207], v[248:251], v[84:87], v[204:207]
    s_nop 2
SM_AF:
    v_fma_f32 v32, v184, s30, -v22
    v_fma_f32 v33, v185, s30, -v22
    v_fma_f32 v34, v186, s30, -v22
    v_fma_f32 v35, v187, s30, -v22
    v_fma_f32 v36, v196, s30, -v22
    v_fma_f32 v37, v197, s30, -v22
    v_fma_f32 v38, v198, s30, -v22
    v_fma_f32 v39, v199, s30, -v22
    v_exp_f32 v32, v32
    v_exp_f32 v33, v33
    v_exp_f32 v34, v34
    v_exp_f32 v35, v35
    v_exp_f32 v36, v36
    v_exp_f32 v37, v37
    v_exp_f32 v38, v38
    v_exp_f32 v39, v39
    v_cvt_pk_bf16_f32 v208, v32, v33
    v_cvt_pk_bf16_f32 v209, v34, v35
    v_add_f32 v32, v32, v33
    v_add_f32 v34, v34, v35
    v_cvt_pk_bf16_f32 v210, v36, v37
    v_cvt_pk_bf16_f32 v211, v38, v39
    v_add_f32 v36, v36, v37
    v_add_f32 v38, v38, v39
    v_add_f32 v32, v32, v34
    v_add_f32 v36, v36, v38
    v_add_f32 v28, v32, v36
    v_fma_f32 v32, v188, s30, -v23
    v_fma_f32 v33, v189, s30, -v23
    v_fma_f32 v34, v190, s30, -v23
    v_fma_f32 v35, v191, s30, -v23
    v_fma_f32 v36, v200, s30, -v23
    v_fma_f32 v37, v201, s30, -v23
    v_fma_f32 v38, v202, s30, -v23
    v_fma_f32 v39, v203, s30, -v23
    v_exp_f32 v32, v32
    v_exp_f32 v33, v33
    v_exp_f32 v34, v34
    v_exp_f32 v35, v35
    v_exp_f32 v36, v36
    v_exp_f32 v37, v37
    v_exp_f32 v38, v38
    v_exp_f32 v39, v39
    v_cvt_pk_bf16_f32 v212, v32, v33
    v_cvt_pk_bf16_f32 v213, v34, v35
    v_add_f32 v32, v32, v33
    v_add_f32 v34, v34, v35
    v_cvt_pk_bf16_f32 v214, v36, v37
    v_cvt_pk_bf16_f32 v215, v38, v39
    v_add_f32 v36, v36, v37
    v_add_f32 v38, v38, v39
    v_add_f32 v32, v32, v34
    v_add_f32 v36, v36, v38
    v_add_f32 v29, v32, v36
    v_fma_f32 v32, v192, s30, -v24
    v_fma_f32 v33, v193, s30, -v24
    v_fma_f32 v34, v194, s30, -v24
    v_fma_f32 v35, v195, s30, -v24
    v_fma_f32 v36, v204, s30, -v24
    v_fma_f32 v37, v205, s30, -v24
    v_fma_f32 v38, v206, s30, -v24
    v_fma_f32 v39, v207, s30, -v24
    v_exp_f32 v32, v32
    v_exp_f32 v33, v33
    v_exp_f32 v34, v34
    v_exp_f32 v35, v35
    v_exp_f32 v36, v36
    v_exp_f32 v37, v37
    v_exp_f32 v38, v38
    v_exp_f32 v39, v39
    v_cvt_pk_bf16_f32 v216, v32, v33
    v_cvt_pk_bf16_f32 v217, v34, v35
    v_add_f32 v32, v32, v33
    v_add_f32 v34, v34, v35
    v_cvt_pk_bf16_f32 v218, v36, v37
    v_cvt_pk_bf16_f32 v219, v38, v39
    v_add_f32 v36, v36, v37
    v_add_f32 v38, v38, v39
    v_add_f32 v32, v32, v34
    v_add_f32 v36, v36, v38
    v_add_f32 v30, v32, v36
    v_max3_f32 v31, v28, v29, v30
    v_cmp_lt_f32 vcc, s31, v31
    s_cbranch_vccnz SLOW_AF
    s_mov_b32 s31, 0x43800000
    v_add_f32 v25, v25, v28
    v_add_f32 v26, v26, v29
    v_add_f32 v27, v27, v30
    s_waitcnt vmcnt(0)
    ds_read_b64_tr_b16 v[220:221], v14
    ds_read_b64_tr_b16 v[222:223], v14 offset:4096
    ds_read_b64_tr_b16 v[224:225], v15
    ds_read_b64_tr_b16 v[226:227], v15 offset:4096
    ds_read_b64_tr_b16 v[228:229], v16
    ds_read_b64_tr_b16 v[230:231], v16 offset:4096
    ds_read_b64_tr_b16 v[232:233], v17
    ds_read_b64_tr_b16 v[234:235], v17 offset:4096
    ds_read_b64_tr_b16 v[236:237], v18
    ds_read_b64_tr_b16 v[238:239], v18 offset:4096
    ds_read_b64_tr_b16 v[240:241], v19
    ds_read_b64_tr_b16 v[242:243], v19 offset:4096
    ds_read_b64_tr_b16 v[244:245], v20
    ds_read_b64_tr_b16 v[246:247], v20 offset:4096
    ds_read_b64_tr_b16 v[248:249], v21
    ds_read_b64_tr_b16 v[250:251], v21 offset:4096
    s_waitcnt lgkmcnt(0)
    v_mfma_f32_16x16x32_bf16 v[88:91], v[220:223], v[208:211], v[88:91]
    v_mfma_f32_16x16x32_bf16 v[92:95], v[220:223], v[212:215], v[92:95]
    v_mfma_f32_16x16x32_bf16 v[96:99], v[220:223], v[216:219], v[96:99]
    v_mfma_f32_16x16x32_bf16 v[100:103], v[224:227], v[208:211], v[100:103]
    v_mfma_f32_16x16x32_bf16 v[104:107], v[224:227], v[212:215], v[104:107]
    v_mfma_f32_16x16x32_bf16 v[108:111], v[224:227], v[216:219], v[108:111]
    v_mfma_f32_16x16x32_bf16 v[112:115], v[228:231], v[208:211], v[112:115]
    v_mfma_f32_16x16x32_bf16 v[116:119], v[228:231], v[212:215], v[116:119]
    v_mfma_f32_16x16x32_bf16 v[120:123], v[228:231], v[216:219], v[120:123]
    v_mfma_f32_16x16x32_bf16 v[124:127], v[232:235], v[208:211], v[124:127]
    v_mfma_f32_16x16x32_bf16 v[128:131], v[232:235], v[212:215], v[128:131]
    v_mfma_f32_16x16x32_bf16 v[132:135], v[232:235], v[216:219], v[132:135]
    v_mfma_f32_16x16x32_bf16 v[136:139], v[236:239], v[208:211], v[136:139]
    v_mfma_f32_16x16x32_bf16 v[140:143], v[236:239], v[212:215], v[140:143]
    v_mfma_f32_16x16x32_bf16 v[144:147], v[236:239], v[216:219], v[144:147]
    v_mfma_f32_16x16x32_bf16 v[148:151], v[240:243], v[208:211], v[148:151]
    v_mfma_f32_16x16x32_bf16 v[152:155], v[240:243], v[212:215], v[152:155]
    v_mfma_f32_16x16x32_bf16 v[156:159], v[240:243], v[216:219], v[156:159]
    v_mfma_f32_16x16x32_bf16 v[160:163], v[244:247], v[208:211], v[160:163]
    v_mfma_f32_16x16x32_bf16 v[164:167], v[244:247], v[212:215], v[164:167]
    v_mfma_f32_16x16x32_bf16 v[168:171], v[244:247], v[216:219], v[168:171]
    v_mfma_f32_16x16x32_bf16 v[172:175], v[248:251], v[208:211], v[172:175]
    v_mfma_f32_16x16x32_bf16 v[176:179], v[248:251], v[212:215], v[176:179]
    v_mfma_f32_16x16x32_bf16 v[180:183], v[248:251], v[216:219], v[180:183]
    s_branch LAST
START_B:
    s_mov_b32 s26, 15
.p2align 3
LOOP_B:
    s_waitcnt vmcnt(0)
    ds_read_b128 v[220:223], v10 offset:0
    ds_read_b128 v[224:227], v11 offset:0
    ds_read_b128 v[228:231], v12 offset:0
    ds_read_b128 v[232:235], v13 offset:0
    ds_read_b128 v[236:239], v10 offset:4096
    ds_read_b128 v[240:243], v11 offset:4096
    ds_read_b128 v[244:247], v12 offset:4096
    ds_read_b128 v[248:251], v13 offset:4096
    s_waitcnt lgkmcnt(0)
    s_mov_b32 m0, s28
    s_add_u32 s34, s25, 0x1000
    buffer_load_dwordx4 v8, s[8:11], s25 offen offset:0 nt lds
    v_mfma_f32_16x16x32_bf16 v[184:187], v[220:223], v[40:43], 0
    v_mfma_f32_16x16x32_bf16 v[196:199], v[236:239], v[40:43], 0
    v_mfma_f32_16x16x32_bf16 v[188:191], v[220:223], v[56:59], 0
    buffer_load_dwordx4 v9, s[8:11], s25 offen offset:1024 nt lds
    v_mfma_f32_16x16x32_bf16 v[200:203], v[236:239], v[56:59], 0
    v_mfma_f32_16x16x32_bf16 v[192:195], v[220:223], v[72:75], 0
    v_mfma_f32_16x16x32_bf16 v[204:207], v[236:239], v[72:75], 0
    buffer_load_dwordx4 v8, s[8:11], s25 offen offset:2048 nt lds
    v_mfma_f32_16x16x32_bf16 v[184:187], v[224:227], v[44:47], v[184:187]
    v_mfma_f32_16x16x32_bf16 v[196:199], v[240:243], v[44:47], v[196:199]
    v_mfma_f32_16x16x32_bf16 v[188:191], v[224:227], v[60:63], v[188:191]
    buffer_load_dwordx4 v9, s[8:11], s25 offen offset:3072 nt lds
    v_mfma_f32_16x16x32_bf16 v[200:203], v[240:243], v[60:63], v[200:203]
    v_mfma_f32_16x16x32_bf16 v[192:195], v[224:227], v[76:79], v[192:195]
    v_mfma_f32_16x16x32_bf16 v[204:207], v[240:243], v[76:79], v[204:207]
    s_add_u32 m0, s28, 0x1000
    s_nop 0
    buffer_load_dwordx4 v8, s[8:11], s34 offen offset:0 nt lds
    v_mfma_f32_16x16x32_bf16 v[184:187], v[228:231], v[48:51], v[184:187]
    v_mfma_f32_16x16x32_bf16 v[196:199], v[244:247], v[48:51], v[196:199]
    v_mfma_f32_16x16x32_bf16 v[188:191], v[228:231], v[64:67], v[188:191]
    buffer_load_dwordx4 v9, s[8:11], s34 offen offset:1024 nt lds
    v_mfma_f32_16x16x32_bf16 v[200:203], v[244:247], v[64:67], v[200:203]
    v_mfma_f32_16x16x32_bf16 v[192:195], v[228:231], v[80:83], v[192:195]
    v_mfma_f32_16x16x32_bf16 v[204:207], v[244:247], v[80:83], v[204:207]
    buffer_load_dwordx4 v8, s[8:11], s34 offen offset:2048 nt lds
    v_mfma_f32_16x16x32_bf16 v[184:187], v[232:235], v[52:55], v[184:187]
    v_mfma_f32_16x16x32_bf16 v[196:199], v[248:251], v[52:55], v[196:199]
    v_mfma_f32_16x16x32_bf16 v[188:191], v[232:235], v[68:71], v[188:191]
    buffer_load_dwordx4 v9, s[8:11], s34 offen offset:3072 nt lds
    v_mfma_f32_16x16x32_bf16 v[200:203], v[248:251], v[68:71], v[200:203]
    v_mfma_f32_16x16x32_bf16 v[192:195], v[232:235], v[84:87], v[192:195]
    v_mfma_f32_16x16x32_bf16 v[204:207], v[248:251], v[84:87], v[204:207]
    s_add_u32 s97, s97, 1
    s_add_u32 s25, s97, s98
    s_and_b32 s25, s25, 3
    s_and_b32 s34, s97, 12
    s_or_b32 s25, s25, s34
    s_lshl_b32 s25, s25, 15
    s_nop 2
SM_BL:
    v_fma_f32 v32, v184, s30, -v22
    v_fma_f32 v33, v185, s30, -v22
    v_fma_f32 v34, v186, s30, -v22
    v_fma_f32 v35, v187, s30, -v22
    v_fma_f32 v36, v196, s30, -v22
    v_fma_f32 v37, v197, s30, -v22
    v_fma_f32 v38, v198, s30, -v22
    v_fma_f32 v39, v199, s30, -v22
    v_exp_f32 v32, v32
    v_exp_f32 v33, v33
    v_exp_f32 v34, v34
    v_exp_f32 v35, v35
    v_exp_f32 v36, v36
    v_exp_f32 v37, v37
    v_exp_f32 v38, v38
    v_exp_f32 v39, v39
    v_cvt_pk_bf16_f32 v208, v32, v33
    v_cvt_pk_bf16_f32 v209, v34, v35
    v_add_f32 v32, v32, v33
    v_add_f32 v34, v34, v35
    v_cvt_pk_bf16_f32 v210, v36, v37
    v_cvt_pk_bf16_f32 v211, v38, v39
    v_add_f32 v36, v36, v37
    v_add_f32 v38, v38, v39
    v_add_f32 v32, v32, v34
    v_add_f32 v36, v36, v38
    v_add_f32 v28, v32, v36
    v_fma_f32 v32, v188, s30, -v23
    v_fma_f32 v33, v189, s30, -v23
    v_fma_f32 v34, v190, s30, -v23
    v_fma_f32 v35, v191, s30, -v23
    v_fma_f32 v36, v200, s30, -v23
    v_fma_f32 v37, v201, s30, -v23
    v_fma_f32 v38, v202, s30, -v23
    v_fma_f32 v39, v203, s30, -v23
    v_exp_f32 v32, v32
    v_exp_f32 v33, v33
    v_exp_f32 v34, v34
    v_exp_f32 v35, v35
    v_exp_f32 v36, v36
    v_exp_f32 v37, v37
    v_exp_f32 v38, v38
    v_exp_f32 v39, v39
    v_cvt_pk_bf16_f32 v212, v32, v33
    v_cvt_pk_bf16_f32 v213, v34, v35
    v_add_f32 v32, v32, v33
    v_add_f32 v34, v34, v35
    v_cvt_pk_bf16_f32 v214, v36, v37
    v_cvt_pk_bf16_f32 v215, v38, v39
    v_add_f32 v36, v36, v37
    v_add_f32 v38, v38, v39
    v_add_f32 v32, v32, v34
    v_add_f32 v36, v36, v38
    v_add_f32 v29, v32, v36
    v_fma_f32 v32, v192, s30, -v24
    v_fma_f32 v33, v193, s30, -v24
    v_fma_f32 v34, v194, s30, -v24
    v_fma_f32 v35, v195, s30, -v24
    v_fma_f32 v36, v204, s30, -v24
    v_fma_f32 v37, v205, s30, -v24
    v_fma_f32 v38, v206, s30, -v24
    v_fma_f32 v39, v207, s30, -v24
    v_exp_f32 v32, v32
    v_exp_f32 v33, v33
    v_exp_f32 v34, v34
    v_exp_f32 v35, v35
    v_exp_f32 v36, v36
    v_exp_f32 v37, v37
    v_exp_f32 v38, v38
    v_exp_f32 v39, v39
    v_cvt_pk_bf16_f32 v216, v32, v33
    v_cvt_pk_bf16_f32 v217, v34, v35
    v_add_f32 v32, v32, v33
    v_add_f32 v34, v34, v35
    v_cvt_pk_bf16_f32 v218, v36, v37
    v_cvt_pk_bf16_f32 v219, v38, v39
    v_add_f32 v36, v36, v37
    v_add_f32 v38, v38, v39
    v_add_f32 v32, v32, v34
    v_add_f32 v36, v36, v38
    v_add_f32 v30, v32, v36
    v_max3_f32 v31, v28, v29, v30
    v_cmp_lt_f32 vcc, s31, v31
    s_cbranch_vccnz SLOW_BL
    s_mov_b32 s31, 0x43800000
    v_add_f32 v25, v25, v28
    v_add_f32 v26, v26, v29
    v_add_f32 v27, v27, v30
    s_waitcnt vmcnt(0)
    ds_read_b64_tr_b16 v[220:221], v14
    ds_read_b64_tr_b16 v[222:223], v14 offset:4096
    ds_read_b64_tr_b16 v[224:225], v15
    ds_read_b64_tr_b16 v[226:227], v15 offset:4096
    ds_read_b64_tr_b16 v[228:229], v16
    ds_read_b64_tr_b16 v[230:231], v16 offset:4096
    ds_read_b64_tr_b16 v[232:233], v17
    ds_read_b64_tr_b16 v[234:235], v17 offset:4096
    ds_read_b64_tr_b16 v[236:237], v18
    ds_read_b64_tr_b16 v[238:239], v18 offset:4096
    ds_read_b64_tr_b16 v[240:241], v19
    ds_read_b64_tr_b16 v[242:243], v19 offset:4096
    ds_read_b64_tr_b16 v[244:245], v20
    ds_read_b64_tr_b16 v[246:247], v20 offset:4096
    ds_read_b64_tr_b16 v[248:249], v21
    ds_read_b64_tr_b16 v[250:251], v21 offset:4096
    s_waitcnt lgkmcnt(0)
    s_mov_b32 m0, s27
    s_add_u32 s34, s24, 0x1000
    buffer_load_dwordx4 v4, s[4:7], s24 offen offset:0 nt lds
    v_mfma_f32_16x16x32_bf16 v[88:91], v[220:223], v[208:211], v[88:91]
    v_mfma_f32_16x16x32_bf16 v[92:95], v[220:223], v[212:215], v[92:95]
    v_mfma_f32_16x16x32_bf16 v[96:99], v[220:223], v[216:219], v[96:99]
    buffer_load_dwordx4 v5, s[4:7], s24 offen offset:1024 nt lds
    v_mfma_f32_16x16x32_bf16 v[100:103], v[224:227], v[208:211], v[100:103]
    v_mfma_f32_16x16x32_bf16 v[104:107], v[224:227], v[212:215], v[104:107]
    v_mfma_f32_16x16x32_bf16 v[108:111], v[224:227], v[216:219], v[108:111]
    buffer_load_dwordx4 v6, s[4:7], s24 offen offset:2048 nt lds
    v_mfma_f32_16x16x32_bf16 v[112:115], v[228:231], v[208:211], v[112:115]
    v_mfma_f32_16x16x32_bf16 v[116:119], v[228:231], v[212:215], v[116:119]
    v_mfma_f32_16x16x32_bf16 v[120:123], v[228:231], v[216:219], v[120:123]
    buffer_load_dwordx4 v7, s[4:7], s24 offen offset:3072 nt lds
    v_mfma_f32_16x16x32_bf16 v[124:127], v[232:235], v[208:211], v[124:127]
    v_mfma_f32_16x16x32_bf16 v[128:131], v[232:235], v[212:215], v[128:131]
    v_mfma_f32_16x16x32_bf16 v[132:135], v[232:235], v[216:219], v[132:135]
    s_add_u32 m0, s27, 0x1000
    s_nop 0
    buffer_load_dwordx4 v4, s[4:7], s34 offen offset:0 nt lds
    v_mfma_f32_16x16x32_bf16 v[136:139], v[236:239], v[208:211], v[136:139]
    v_mfma_f32_16x16x32_bf16 v[140:143], v[236:239], v[212:215], v[140:143]
    v_mfma_f32_16x16x32_bf16 v[144:147], v[236:239], v[216:219], v[144:147]
    buffer_load_dwordx4 v5, s[4:7], s34 offen offset:1024 nt lds
    v_mfma_f32_16x16x32_bf16 v[148:151], v[240:243], v[208:211], v[148:151]
    v_mfma_f32_16x16x32_bf16 v[152:155], v[240:243], v[212:215], v[152:155]
    v_mfma_f32_16x16x32_bf16 v[156:159], v[240:243], v[216:219], v[156:159]
    buffer_load_dwordx4 v6, s[4:7], s34 offen offset:2048 nt lds
    v_mfma_f32_16x16x32_bf16 v[160:163], v[244:247], v[208:211], v[160:163]
    v_mfma_f32_16x16x32_bf16 v[164:167], v[244:247], v[212:215], v[164:167]
    v_mfma_f32_16x16x32_bf16 v[168:171], v[244:247], v[216:219], v[168:171]
    buffer_load_dwordx4 v7, s[4:7], s34 offen offset:3072 nt lds
    v_mfma_f32_16x16x32_bf16 v[172:175], v[248:251], v[208:211], v[172:175]
    v_mfma_f32_16x16x32_bf16 v[176:179], v[248:251], v[212:215], v[176:179]
    v_mfma_f32_16x16x32_bf16 v[180:183], v[248:251], v[216:219], v[180:183]
    s_add_u32 s96, s96, 1
    s_add_u32 s24, s96, s98
    s_and_b32 s24, s24, 3
    s_and_b32 s34, s96, 12
    s_or_b32 s24, s24, s34
    s_lshl_b32 s24, s24, 15
    s_sub_u32 s26, s26, 1
    s_cmp_lg_u32 s26, 0
    s_cbranch_scc1 LOOP_B
    s_waitcnt vmcnt(0)
    ds_read_b128 v[220:223], v10 offset:0
    ds_read_b128 v[224:227], v11 offset:0
    ds_read_b128 v[228:231], v12 offset:0
    ds_read_b128 v[232:235], v13 offset:0
    ds_read_b128 v[236:239], v10 offset:4096
    ds_read_b128 v[240:243], v11 offset:4096
    ds_read_b128 v[244:247], v12 offset:4096
    ds_read_b128 v[248:251], v13 offset:4096
    s_waitcnt lgkmcnt(0)
    s_mov_b32 m0, s28
    s_add_u32 s34, s25, 0x1000
    buffer_load_dwordx4 v8, s[8:11], s25 offen offset:0 nt lds
    v_mfma_f32_16x16x32_bf16 v[184:187], v[220:223], v[40:43], 0
    v_mfma_f32_16x16x32_bf16 v[196:199], v[236:239], v[40:43], 0
    v_mfma_f32_16x16x32_bf16 v[188:191], v[220:223], v[56:59], 0
    buffer_load_dwordx4 v9, s[8:11], s25 offen offset:1024 nt lds
    v_mfma_f32_16x16x32_bf16 v[200:203], v[236:239], v[56:59], 0
    v_mfma_f32_16x16x32_bf16 v[192:195], v[220:223], v[72:75], 0
    v_mfma_f32_16x16x32_bf16 v[204:207], v[236:239], v[72:75], 0
    buffer_load_dwordx4 v8, s[8:11], s25 offen offset:2048 nt lds
    v_mfma_f32_16x16x32_bf16 v[184:187], v[224:227], v[44:47], v[184:187]
    v_mfma_f32_16x16x32_bf16 v[196:199], v[240:243], v[44:47], v[196:199]
    v_mfma_f32_16x16x32_bf16 v[188:191], v[224:227], v[60:63], v[188:191]
    buffer_load_dwordx4 v9, s[8:11], s25 offen offset:3072 nt lds
    v_mfma_f32_16x16x32_bf16 v[200:203], v[240:243], v[60:63], v[200:203]
    v_mfma_f32_16x16x32_bf16 v[192:195], v[224:227], v[76:79], v[192:195]
    v_mfma_f32_16x16x32_bf16 v[204:207], v[240:243], v[76:79], v[204:207]
    s_add_u32 m0, s28, 0x1000
    s_nop 0
    buffer_load_dwordx4 v8, s[8:11], s34 offen offset:0 nt lds
    v_mfma_f32_16x16x32_bf16 v[184:187], v[228:231], v[48:51], v[184:187]
    v_mfma_f32_16x16x32_bf16 v[196:199], v[244:247], v[48:51], v[196:199]
    v_mfma_f32_16x16x32_bf16 v[188:191], v[228:231], v[64:67], v[188:191]
    buffer_load_dwordx4 v9, s[8:11], s34 offen offset:1024 nt lds
    v_mfma_f32_16x16x32_bf16 v[200:203], v[244:247], v[64:67], v[200:203]
    v_mfma_f32_16x16x32_bf16 v[192:195], v[228:231], v[80:83], v[192:195]
    v_mfma_f32_16x16x32_bf16 v[204:207], v[244:247], v[80:83], v[204:207]
    buffer_load_dwordx4 v8, s[8:11], s34 offen offset:2048 nt lds
    v_mfma_f32_16x16x32_bf16 v[184:187], v[232:235], v[52:55], v[184:187]
    v_mfma_f32_16x16x32_bf16 v[196:199], v[248:251], v[52:55], v[196:199]
    v_mfma_f32_16x16x32_bf16 v[188:191], v[232:235], v[68:71], v[188:191]
    buffer_load_dwordx4 v9, s[8:11], s34 offen offset:3072 nt lds
    v_mfma_f32_16x16x32_bf16 v[200:203], v[248:251], v[68:71], v[200:203]
    v_mfma_f32_16x16x32_bf16 v[192:195], v[232:235], v[84:87], v[192:195]
    v_mfma_f32_16x16x32_bf16 v[204:207], v[248:251], v[84:87], v[204:207]
    s_add_u32 s97, s97, 1
    s_add_u32 s25, s97, s98
    s_and_b32 s25, s25, 3
    s_and_b32 s34, s97, 12
    s_or_b32 s25, s25, s34
    s_lshl_b32 s25, s25, 15
    s_nop 2
SM_BF:
    v_fma_f32 v32, v184, s30, -v22
    v_fma_f32 v33, v185, s30, -v22
    v_fma_f32 v34, v186, s30, -v22
    v_fma_f32 v35, v187, s30, -v22
    v_fma_f32 v36, v196, s30, -v22
    v_fma_f32 v37, v197, s30, -v22
    v_fma_f32 v38, v198, s30, -v22
    v_fma_f32 v39, v199, s30, -v22
    v_exp_f32 v32, v32
    v_exp_f32 v33, v33
    v_exp_f32 v34, v34
    v_exp_f32 v35, v35
    v_exp_f32 v36, v36
    v_exp_f32 v37, v37
    v_exp_f32 v38, v38
    v_exp_f32 v39, v39
    v_cvt_pk_bf16_f32 v208, v32, v33
    v_cvt_pk_bf16_f32 v209, v34, v35
    v_add_f32 v32, v32, v33
    v_add_f32 v34, v34, v35
    v_cvt_pk_bf16_f32 v210, v36, v37
    v_cvt_pk_bf16_f32 v211, v38, v39
    v_add_f32 v36, v36, v37
    v_add_f32 v38, v38, v39
    v_add_f32 v32, v32, v34
    v_add_f32 v36, v36, v38
    v_add_f32 v28, v32, v36
    v_fma_f32 v32, v188, s30, -v23
    v_fma_f32 v33, v189, s30, -v23
    v_fma_f32 v34, v190, s30, -v23
    v_fma_f32 v35, v191, s30, -v23
    v_fma_f32 v36, v200, s30, -v23
    v_fma_f32 v37, v201, s30, -v23
    v_fma_f32 v38, v202, s30, -v23
    v_fma_f32 v39, v203, s30, -v23
    v_exp_f32 v32, v32
    v_exp_f32 v33, v33
    v_exp_f32 v34, v34
    v_exp_f32 v35, v35
    v_exp_f32 v36, v36
    v_exp_f32 v37, v37
    v_exp_f32 v38, v38
    v_exp_f32 v39, v39
    v_cvt_pk_bf16_f32 v212, v32, v33
    v_cvt_pk_bf16_f32 v213, v34, v35
    v_add_f32 v32, v32, v33
    v_add_f32 v34, v34, v35
    v_cvt_pk_bf16_f32 v214, v36, v37
    v_cvt_pk_bf16_f32 v215, v38, v39
    v_add_f32 v36, v36, v37
    v_add_f32 v38, v38, v39
    v_add_f32 v32, v32, v34
    v_add_f32 v36, v36, v38
    v_add_f32 v29, v32, v36
    v_fma_f32 v32, v192, s30, -v24
    v_fma_f32 v33, v193, s30, -v24
    v_fma_f32 v34, v194, s30, -v24
    v_fma_f32 v35, v195, s30, -v24
    v_fma_f32 v36, v204, s30, -v24
    v_fma_f32 v37, v205, s30, -v24
    v_fma_f32 v38, v206, s30, -v24
    v_fma_f32 v39, v207, s30, -v24
    v_exp_f32 v32, v32
    v_exp_f32 v33, v33
    v_exp_f32 v34, v34
    v_exp_f32 v35, v35
    v_exp_f32 v36, v36
    v_exp_f32 v37, v37
    v_exp_f32 v38, v38
    v_exp_f32 v39, v39
    v_cvt_pk_bf16_f32 v216, v32, v33
    v_cvt_pk_bf16_f32 v217, v34, v35
    v_add_f32 v32, v32, v33
    v_add_f32 v34, v34, v35
    v_cvt_pk_bf16_f32 v218, v36, v37
    v_cvt_pk_bf16_f32 v219, v38, v39
    v_add_f32 v36, v36, v37
    v_add_f32 v38, v38, v39
    v_add_f32 v32, v32, v34
    v_add_f32 v36, v36, v38
    v_add_f32 v30, v32, v36
    v_max3_f32 v31, v28, v29, v30
    v_cmp_lt_f32 vcc, s31, v31
    s_cbranch_vccnz SLOW_BF
    s_mov_b32 s31, 0x43800000
    v_add_f32 v25, v25, v28
    v_add_f32 v26, v26, v29
    v_add_f32 v27, v27, v30
    s_waitcnt vmcnt(0)
    ds_read_b64_tr_b16 v[220:221], v14
    ds_read_b64_tr_b16 v[222:223], v14 offset:4096
    ds_read_b64_tr_b16 v[224:225], v15
    ds_read_b64_tr_b16 v[226:227], v15 offset:4096
    ds_read_b64_tr_b16 v[228:229], v16
    ds_read_b64_tr_b16 v[230:231], v16 offset:4096
    ds_read_b64_tr_b16 v[232:233], v17
    ds_read_b64_tr_b16 v[234:235], v17 offset:4096
    ds_read_b64_tr_b16 v[236:237], v18
    ds_read_b64_tr_b16 v[238:239], v18 offset:4096
    ds_read_b64_tr_b16 v[240:241], v19
    ds_read_b64_tr_b16 v[242:243], v19 offset:4096
    ds_read_b64_tr_b16 v[244:245], v20
    ds_read_b64_tr_b16 v[246:247], v20 offset:4096
    ds_read_b64_tr_b16 v[248:249], v21
    ds_read_b64_tr_b16 v[250:251], v21 offset:4096
    s_waitcnt lgkmcnt(0)
    v_mfma_f32_16x16x32_bf16 v[88:91], v[220:223], v[208:211], v[88:91]
    v_mfma_f32_16x16x32_bf16 v[92:95], v[220:223], v[212:215], v[92:95]
    v_mfma_f32_16x16x32_bf16 v[96:99], v[220:223], v[216:219], v[96:99]
    v_mfma_f32_16x16x32_bf16 v[100:103], v[224:227], v[208:211], v[100:103]
    v_mfma_f32_16x16x32_bf16 v[104:107], v[224:227], v[212:215], v[104:107]
    v_mfma_f32_16x16x32_bf16 v[108:111], v[224:227], v[216:219], v[108:111]
    v_mfma_f32_16x16x32_bf16 v[112:115], v[228:231], v[208:211], v[112:115]
    v_mfma_f32_16x16x32_bf16 v[116:119], v[228:231], v[212:215], v[116:119]
    v_mfma_f32_16x16x32_bf16 v[120:123], v[228:231], v[216:219], v[120:123]
    v_mfma_f32_16x16x32_bf16 v[124:127], v[232:235], v[208:211], v[124:127]
    v_mfma_f32_16x16x32_bf16 v[128:131], v[232:235], v[212:215], v[128:131]
    v_mfma_f32_16x16x32_bf16 v[132:135], v[232:235], v[216:219], v[132:135]
    v_mfma_f32_16x16x32_bf16 v[136:139], v[236:239], v[208:211], v[136:139]
    v_mfma_f32_16x16x32_bf16 v[140:143], v[236:239], v[212:215], v[140:143]
    v_mfma_f32_16x16x32_bf16 v[144:147], v[236:239], v[216:219], v[144:147]
    v_mfma_f32_16x16x32_bf16 v[148:151], v[240:243], v[208:211], v[148:151]
    v_mfma_f32_16x16x32_bf16 v[152:155], v[240:243], v[212:215], v[152:155]
    v_mfma_f32_16x16x32_bf16 v[156:159], v[240:243], v[216:219], v[156:159]
    v_mfma_f32_16x16x32_bf16 v[160:163], v[244:247], v[208:211], v[160:163]
    v_mfma_f32_16x16x32_bf16 v[164:167], v[244:247], v[212:215], v[164:167]
    v_mfma_f32_16x16x32_bf16 v[168:171], v[244:247], v[216:219], v[168:171]
    v_mfma_f32_16x16x32_bf16 v[172:175], v[248:251], v[208:211], v[172:175]
    v_mfma_f32_16x16x32_bf16 v[176:179], v[248:251], v[212:215], v[176:179]
    v_mfma_f32_16x16x32_bf16 v[180:183], v[248:251], v[216:219], v[180:183]
LAST:
    v_mov_b32 v31, v25
    s_nop 1
    v_permlane32_swap_b32 v25, v31
    s_nop 1
    v_add_f32 v25, v25, v31
    v_mov_b32 v31, v25
    s_nop 1
    v_permlane16_swap_b32 v25, v31
    s_nop 1
    v_add_f32 v25, v25, v31
    v_mov_b32 v31, v26
    s_nop 1
    v_permlane32_swap_b32 v26, v31
    s_nop 1
    v_add_f32 v26, v26, v31
    v_mov_b32 v31, v26
    s_nop 1
    v_permlane16_swap_b32 v26, v31
    s_nop 1
    v_add_f32 v26, v26, v31
    v_mov_b32 v31, v27
    s_nop 1
    v_permlane32_swap_b32 v27, v31
    s_nop 1
    v_add_f32 v27, v27, v31
    v_mov_b32 v31, v27
    s_nop 1
    v_permlane16_swap_b32 v27, v31
    s_nop 1
    v_add_f32 v27, v27, v31
    v_lshlrev_b32 v1, 4, v0
    v_add_u32 v3, 65536, v1
    v_lshlrev_b32 v2, 2, v0
    v_add_u32 v2, 65536, v2
    s_lshl_b32 s54, s23, 3
    s_add_u32 s54, s54, s21
    s_mul_i32 s54, s54, 393216
    s_lshl_b32 s55, s22, 2
    s_add_u32 s55, s55, s20
    s_lshl_b32 s55, s55, 10
    s_add_u32 s54, s54, s55
    s_add_u32 s12, s70, s54
    s_addc_u32 s13, s71, 0
    s_mov_b32 s14, 263168
    s_mov_b32 s15, 0x20000
    s_cmp_eq_u32 s20, 0
    s_cbranch_scc0 EP_1
    ds_write_b32 v2, v22 offset:2048
    ds_write_b32 v2, v25 offset:2816
    ds_write_b32 v2, v23 offset:2304
    ds_write_b32 v2, v26 offset:3072
    ds_write_b32 v2, v24 offset:2560
    ds_write_b32 v2, v27 offset:3328
    ds_write_b128 v1, v[112:115] offset:0
    ds_write_b128 v1, v[116:119] offset:1024
    ds_write_b128 v1, v[120:123] offset:2048
    ds_write_b128 v1, v[124:127] offset:3072
    ds_write_b128 v1, v[128:131] offset:4096
    ds_write_b128 v1, v[132:135] offset:5120
    ds_write_b128 v1, v[136:139] offset:6144
    ds_write_b128 v1, v[140:143] offset:7168
    ds_write_b128 v1, v[144:147] offset:32768
    ds_write_b128 v1, v[148:151] offset:33792
    ds_write_b128 v1, v[152:155] offset:34816
    ds_write_b128 v1, v[156:159] offset:35840
    ds_write_b128 v1, v[160:163] offset:36864
    ds_write_b128 v1, v[164:167] offset:37888
    ds_write_b128 v1, v[168:171] offset:38912
    ds_write_b128 v1, v[172:175] offset:39936
    ds_write_b128 v3, v[176:179] offset:0
    ds_write_b128 v3, v[180:183] offset:1024
    s_waitcnt lgkmcnt(0)
    s_barrier
    ds_read_b32 v220, v2 offset:2048
    ds_read_b32 v221, v2 offset:2304
    ds_read_b32 v222, v2 offset:2560
    ds_read_b32 v223, v2 offset:2816
    ds_read_b32 v224, v2 offset:3072
    ds_read_b32 v225, v2 offset:3328
    ds_read_b32 v226, v2 offset:6144
    ds_read_b32 v227, v2 offset:6400
    ds_read_b32 v228, v2 offset:6656
    ds_read_b32 v229, v2 offset:6912
    ds_read_b32 v230, v2 offset:7168
    ds_read_b32 v231, v2 offset:7424
    ds_read_b32 v232, v2 offset:10240
    ds_read_b32 v233, v2 offset:10496
    ds_read_b32 v234, v2 offset:10752
    ds_read_b32 v235, v2 offset:11008
    ds_read_b32 v236, v2 offset:11264
    ds_read_b32 v237, v2 offset:11520
    ds_read_b32 v238, v2 offset:14336
    ds_read_b32 v239, v2 offset:14592
    ds_read_b32 v240, v2 offset:14848
    ds_read_b32 v241, v2 offset:15104
    ds_read_b32 v242, v2 offset:15360
    ds_read_b32 v243, v2 offset:15616
    ds_read_b128 v[40:43], v1 offset:24576
    ds_read_b128 v[44:47], v1 offset:25600
    ds_read_b128 v[48:51], v1 offset:26624
    ds_read_b128 v[52:55], v1 offset:27648
    ds_read_b128 v[56:59], v1 offset:28672
    ds_read_b128 v[60:63], v1 offset:29696
    ds_read_b128 v[64:67], v1 offset:22528
    ds_read_b128 v[68:71], v1 offset:23552
    ds_read_b128 v[72:75], v1 offset:49152
    ds_read_b128 v[76:79], v1 offset:50176
    ds_read_b128 v[80:83], v1 offset:51200
    ds_read_b128 v[84:87], v1 offset:52224
    ds_read_b128 v[184:187], v1 offset:45056
    ds_read_b128 v[188:191], v1 offset:46080
    ds_read_b128 v[192:195], v1 offset:47104
    ds_read_b128 v[196:199], v1 offset:48128
    ds_read_b128 v[200:203], v3 offset:4096
    ds_read_b128 v[204:207], v3 offset:5120
    s_waitcnt lgkmcnt(0)
    v_max3_f32 v32, v220, v226, v232
    v_max_f32 v32, v32, v238
    v_sub_f32 v220, v220, v32
    v_sub_f32 v226, v226, v32
    v_sub_f32 v232, v232, v32
    v_sub_f32 v238, v238, v32
    v_exp_f32 v220, v220
    v_exp_f32 v226, v226
    v_exp_f32 v232, v232
    v_exp_f32 v238, v238
    s_nop 0
    v_mul_f32 v32, v220, v223
    v_fma_f32 v32, v226, v229, v32
    v_fma_f32 v32, v232, v235, v32
    v_fma_f32 v32, v238, v241, v32
    v_rcp_f32 v32, v32
    s_nop 0
    v_mul_f32 v220, v220, v32
    v_mul_f32 v226, v226, v32
    v_mul_f32 v232, v232, v32
    v_mul_f32 v238, v238, v32
    v_mul_f32 v88, v88, v220
    v_mul_f32 v89, v89, v220
    v_mul_f32 v90, v90, v220
    v_mul_f32 v91, v91, v220
    v_fma_f32 v88, v184, v226, v88
    v_fma_f32 v89, v185, v226, v89
    v_fma_f32 v90, v186, v226, v90
    v_fma_f32 v91, v187, v226, v91
    v_fma_f32 v88, v64, v232, v88
    v_fma_f32 v89, v65, v232, v89
    v_fma_f32 v90, v66, v232, v90
    v_fma_f32 v91, v67, v232, v91
    v_fma_f32 v88, v40, v238, v88
    v_fma_f32 v89, v41, v238, v89
    v_fma_f32 v90, v42, v238, v90
    v_fma_f32 v91, v43, v238, v91
    v_mul_f32 v100, v100, v220
    v_mul_f32 v101, v101, v220
    v_mul_f32 v102, v102, v220
    v_mul_f32 v103, v103, v220
    v_fma_f32 v100, v196, v226, v100
    v_fma_f32 v101, v197, v226, v101
    v_fma_f32 v102, v198, v226, v102
    v_fma_f32 v103, v199, v226, v103
    v_fma_f32 v100, v76, v232, v100
    v_fma_f32 v101, v77, v232, v101
    v_fma_f32 v102, v78, v232, v102
    v_fma_f32 v103, v79, v232, v103
    v_fma_f32 v100, v52, v238, v100
    v_fma_f32 v101, v53, v238, v101
    v_fma_f32 v102, v54, v238, v102
    v_fma_f32 v103, v55, v238, v103
    v_cvt_pk_bf16_f32 v208, v88, v89
    v_cvt_pk_bf16_f32 v209, v90, v91
    v_cvt_pk_bf16_f32 v210, v100, v101
    v_cvt_pk_bf16_f32 v211, v102, v103
    s_mov_b32 s34, 0
    buffer_store_dwordx4 v[208:211], v1, s[12:15], s34 offen sc1
    v_max3_f32 v33, v221, v227, v233
    v_max_f32 v33, v33, v239
    v_sub_f32 v221, v221, v33
    v_sub_f32 v227, v227, v33
    v_sub_f32 v233, v233, v33
    v_sub_f32 v239, v239, v33
    v_exp_f32 v221, v221
    v_exp_f32 v227, v227
    v_exp_f32 v233, v233
    v_exp_f32 v239, v239
    s_nop 0
    v_mul_f32 v33, v221, v224
    v_fma_f32 v33, v227, v230, v33
    v_fma_f32 v33, v233, v236, v33
    v_fma_f32 v33, v239, v242, v33
    v_rcp_f32 v33, v33
    s_nop 0
    v_mul_f32 v221, v221, v33
    v_mul_f32 v227, v227, v33
    v_mul_f32 v233, v233, v33
    v_mul_f32 v239, v239, v33
    v_mul_f32 v92, v92, v221
    v_mul_f32 v93, v93, v221
    v_mul_f32 v94, v94, v221
    v_mul_f32 v95, v95, v221
    v_fma_f32 v92, v188, v227, v92
    v_fma_f32 v93, v189, v227, v93
    v_fma_f32 v94, v190, v227, v94
    v_fma_f32 v95, v191, v227, v95
    v_fma_f32 v92, v68, v233, v92
    v_fma_f32 v93, v69, v233, v93
    v_fma_f32 v94, v70, v233, v94
    v_fma_f32 v95, v71, v233, v95
    v_fma_f32 v92, v44, v239, v92
    v_fma_f32 v93, v45, v239, v93
    v_fma_f32 v94, v46, v239, v94
    v_fma_f32 v95, v47, v239, v95
    v_mul_f32 v104, v104, v221
    v_mul_f32 v105, v105, v221
    v_mul_f32 v106, v106, v221
    v_mul_f32 v107, v107, v221
    v_fma_f32 v104, v200, v227, v104
    v_fma_f32 v105, v201, v227, v105
    v_fma_f32 v106, v202, v227, v106
    v_fma_f32 v107, v203, v227, v107
    v_fma_f32 v104, v80, v233, v104
    v_fma_f32 v105, v81, v233, v105
    v_fma_f32 v106, v82, v233, v106
    v_fma_f32 v107, v83, v233, v107
    v_fma_f32 v104, v56, v239, v104
    v_fma_f32 v105, v57, v239, v105
    v_fma_f32 v106, v58, v239, v106
    v_fma_f32 v107, v59, v239, v107
    v_cvt_pk_bf16_f32 v212, v92, v93
    v_cvt_pk_bf16_f32 v213, v94, v95
    v_cvt_pk_bf16_f32 v214, v104, v105
    v_cvt_pk_bf16_f32 v215, v106, v107
    s_mov_b32 s34, 131072
    buffer_store_dwordx4 v[212:215], v1, s[12:15], s34 offen sc1
    v_max3_f32 v34, v222, v228, v234
    v_max_f32 v34, v34, v240
    v_sub_f32 v222, v222, v34
    v_sub_f32 v228, v228, v34
    v_sub_f32 v234, v234, v34
    v_sub_f32 v240, v240, v34
    v_exp_f32 v222, v222
    v_exp_f32 v228, v228
    v_exp_f32 v234, v234
    v_exp_f32 v240, v240
    s_nop 0
    v_mul_f32 v34, v222, v225
    v_fma_f32 v34, v228, v231, v34
    v_fma_f32 v34, v234, v237, v34
    v_fma_f32 v34, v240, v243, v34
    v_rcp_f32 v34, v34
    s_nop 0
    v_mul_f32 v222, v222, v34
    v_mul_f32 v228, v228, v34
    v_mul_f32 v234, v234, v34
    v_mul_f32 v240, v240, v34
    v_mul_f32 v96, v96, v222
    v_mul_f32 v97, v97, v222
    v_mul_f32 v98, v98, v222
    v_mul_f32 v99, v99, v222
    v_fma_f32 v96, v192, v228, v96
    v_fma_f32 v97, v193, v228, v97
    v_fma_f32 v98, v194, v228, v98
    v_fma_f32 v99, v195, v228, v99
    v_fma_f32 v96, v72, v234, v96
    v_fma_f32 v97, v73, v234, v97
    v_fma_f32 v98, v74, v234, v98
    v_fma_f32 v99, v75, v234, v99
    v_fma_f32 v96, v48, v240, v96
    v_fma_f32 v97, v49, v240, v97
    v_fma_f32 v98, v50, v240, v98
    v_fma_f32 v99, v51, v240, v99
    v_mul_f32 v108, v108, v222
    v_mul_f32 v109, v109, v222
    v_mul_f32 v110, v110, v222
    v_mul_f32 v111, v111, v222
    v_fma_f32 v108, v204, v228, v108
    v_fma_f32 v109, v205, v228, v109
    v_fma_f32 v110, v206, v228, v110
    v_fma_f32 v111, v207, v228, v111
    v_fma_f32 v108, v84, v234, v108
    v_fma_f32 v109, v85, v234, v109
    v_fma_f32 v110, v86, v234, v110
    v_fma_f32 v111, v87, v234, v111
    v_fma_f32 v108, v60, v240, v108
    v_fma_f32 v109, v61, v240, v109
    v_fma_f32 v110, v62, v240, v110
    v_fma_f32 v111, v63, v240, v111
    v_cvt_pk_bf16_f32 v216, v96, v97
    v_cvt_pk_bf16_f32 v217, v98, v99
    v_cvt_pk_bf16_f32 v218, v108, v109
    v_cvt_pk_bf16_f32 v219, v110, v111
    s_mov_b32 s34, 262144
    buffer_store_dwordx4 v[216:219], v1, s[12:15], s34 offen sc1
    s_branch EP_END
EP_1:
    s_cmp_eq_u32 s20, 1
    s_cbranch_scc0 EP_2
    ds_write_b32 v2, v22 offset:6144
    ds_write_b32 v2, v25 offset:6912
    ds_write_b32 v2, v23 offset:6400
    ds_write_b32 v2, v26 offset:7168
    ds_write_b32 v2, v24 offset:6656
    ds_write_b32 v2, v27 offset:7424
    ds_write_b128 v1, v[136:139] offset:8192
    ds_write_b128 v1, v[140:143] offset:9216
    ds_write_b128 v1, v[144:147] offset:10240
    ds_write_b128 v1, v[148:151] offset:11264
    ds_write_b128 v1, v[152:155] offset:12288
    ds_write_b128 v1, v[156:159] offset:13312
    ds_write_b128 v1, v[160:163] offset:14336
    ds_write_b128 v1, v[164:167] offset:15360
    ds_write_b128 v1, v[168:171] offset:40960
    ds_write_b128 v1, v[172:175] offset:41984
    ds_write_b128 v1, v[176:179] offset:43008
    ds_write_b128 v1, v[180:183] offset:44032
    ds_write_b128 v1, v[88:91] offset:45056
    ds_write_b128 v1, v[92:95] offset:46080
    ds_write_b128 v1, v[96:99] offset:47104
    ds_write_b128 v1, v[100:103] offset:48128
    ds_write_b128 v3, v[104:107] offset:4096
    ds_write_b128 v3, v[108:111] offset:5120
    s_waitcnt lgkmcnt(0)
    s_barrier
    ds_read_b32 v220, v2 offset:2048
    ds_read_b32 v221, v2 offset:2304
    ds_read_b32 v222, v2 offset:2560
    ds_read_b32 v223, v2 offset:2816
    ds_read_b32 v224, v2 offset:3072
    ds_read_b32 v225, v2 offset:3328
    ds_read_b32 v226, v2 offset:6144
    ds_read_b32 v227, v2 offset:6400
    ds_read_b32 v228, v2 offset:6656
    ds_read_b32 v229, v2 offset:6912
    ds_read_b32 v230, v2 offset:7168
    ds_read_b32 v231, v2 offset:7424
    ds_read_b32 v232, v2 offset:10240
    ds_read_b32 v233, v2 offset:10496
    ds_read_b32 v234, v2 offset:10752
    ds_read_b32 v235, v2 offset:11008
    ds_read_b32 v236, v2 offset:11264
    ds_read_b32 v237, v2 offset:11520
    ds_read_b32 v238, v2 offset:14336
    ds_read_b32 v239, v2 offset:14592
    ds_read_b32 v240, v2 offset:14848
    ds_read_b32 v241, v2 offset:15104
    ds_read_b32 v242, v2 offset:15360
    ds_read_b32 v243, v2 offset:15616
    ds_read_b128 v[40:43], v1 offset:0
    ds_read_b128 v[44:47], v1 offset:1024
    ds_read_b128 v[48:51], v1 offset:2048
    ds_read_b128 v[52:55], v1 offset:3072
    ds_read_b128 v[56:59], v1 offset:4096
    ds_read_b128 v[60:63], v1 offset:5120
    ds_read_b128 v[64:67], v1 offset:30720
    ds_read_b128 v[68:71], v1 offset:31744
    ds_read_b128 v[72:75], v1 offset:57344
    ds_read_b128 v[76:79], v1 offset:58368
    ds_read_b128 v[80:83], v1 offset:59392
    ds_read_b128 v[84:87], v1 offset:60416
    ds_read_b128 v[184:187], v1 offset:53248
    ds_read_b128 v[188:191], v1 offset:54272
    ds_read_b128 v[192:195], v1 offset:55296
    ds_read_b128 v[196:199], v1 offset:56320
    ds_read_b128 v[200:203], v3 offset:8192
    ds_read_b128 v[204:207], v3 offset:9216
    s_waitcnt lgkmcnt(0)
    v_max3_f32 v32, v220, v226, v232
    v_max_f32 v32, v32, v238
    v_sub_f32 v220, v220, v32
    v_sub_f32 v226, v226, v32
    v_sub_f32 v232, v232, v32
    v_sub_f32 v238, v238, v32
    v_exp_f32 v220, v220
    v_exp_f32 v226, v226
    v_exp_f32 v232, v232
    v_exp_f32 v238, v238
    s_nop 0
    v_mul_f32 v32, v220, v223
    v_fma_f32 v32, v226, v229, v32
    v_fma_f32 v32, v232, v235, v32
    v_fma_f32 v32, v238, v241, v32
    v_rcp_f32 v32, v32
    s_nop 0
    v_mul_f32 v220, v220, v32
    v_mul_f32 v226, v226, v32
    v_mul_f32 v232, v232, v32
    v_mul_f32 v238, v238, v32
    v_mul_f32 v112, v112, v226
    v_mul_f32 v113, v113, v226
    v_mul_f32 v114, v114, v226
    v_mul_f32 v115, v115, v226
    v_fma_f32 v112, v40, v220, v112
    v_fma_f32 v113, v41, v220, v113
    v_fma_f32 v114, v42, v220, v114
    v_fma_f32 v115, v43, v220, v115
    v_fma_f32 v112, v184, v232, v112
    v_fma_f32 v113, v185, v232, v113
    v_fma_f32 v114, v186, v232, v114
    v_fma_f32 v115, v187, v232, v115
    v_fma_f32 v112, v64, v238, v112
    v_fma_f32 v113, v65, v238, v113
    v_fma_f32 v114, v66, v238, v114
    v_fma_f32 v115, v67, v238, v115
    v_mul_f32 v124, v124, v226
    v_mul_f32 v125, v125, v226
    v_mul_f32 v126, v126, v226
    v_mul_f32 v127, v127, v226
    v_fma_f32 v124, v52, v220, v124
    v_fma_f32 v125, v53, v220, v125
    v_fma_f32 v126, v54, v220, v126
    v_fma_f32 v127, v55, v220, v127
    v_fma_f32 v124, v196, v232, v124
    v_fma_f32 v125, v197, v232, v125
    v_fma_f32 v126, v198, v232, v126
    v_fma_f32 v127, v199, v232, v127
    v_fma_f32 v124, v76, v238, v124
    v_fma_f32 v125, v77, v238, v125
    v_fma_f32 v126, v78, v238, v126
    v_fma_f32 v127, v79, v238, v127
    v_cvt_pk_bf16_f32 v208, v112, v113
    v_cvt_pk_bf16_f32 v209, v114, v115
    v_cvt_pk_bf16_f32 v210, v124, v125
    v_cvt_pk_bf16_f32 v211, v126, v127
    s_mov_b32 s34, 0
    buffer_store_dwordx4 v[208:211], v1, s[12:15], s34 offen sc1
    v_max3_f32 v33, v221, v227, v233
    v_max_f32 v33, v33, v239
    v_sub_f32 v221, v221, v33
    v_sub_f32 v227, v227, v33
    v_sub_f32 v233, v233, v33
    v_sub_f32 v239, v239, v33
    v_exp_f32 v221, v221
    v_exp_f32 v227, v227
    v_exp_f32 v233, v233
    v_exp_f32 v239, v239
    s_nop 0
    v_mul_f32 v33, v221, v224
    v_fma_f32 v33, v227, v230, v33
    v_fma_f32 v33, v233, v236, v33
    v_fma_f32 v33, v239, v242, v33
    v_rcp_f32 v33, v33
    s_nop 0
    v_mul_f32 v221, v221, v33
    v_mul_f32 v227, v227, v33
    v_mul_f32 v233, v233, v33
    v_mul_f32 v239, v239, v33
    v_mul_f32 v116, v116, v227
    v_mul_f32 v117, v117, v227
    v_mul_f32 v118, v118, v227
    v_mul_f32 v119, v119, v227
    v_fma_f32 v116, v44, v221, v116
    v_fma_f32 v117, v45, v221, v117
    v_fma_f32 v118, v46, v221, v118
    v_fma_f32 v119, v47, v221, v119
    v_fma_f32 v116, v188, v233, v116
    v_fma_f32 v117, v189, v233, v117
    v_fma_f32 v118, v190, v233, v118
    v_fma_f32 v119, v191, v233, v119
    v_fma_f32 v116, v68, v239, v116
    v_fma_f32 v117, v69, v239, v117
    v_fma_f32 v118, v70, v239, v118
    v_fma_f32 v119, v71, v239, v119
    v_mul_f32 v128, v128, v227
    v_mul_f32 v129, v129, v227
    v_mul_f32 v130, v130, v227
    v_mul_f32 v131, v131, v227
    v_fma_f32 v128, v56, v221, v128
    v_fma_f32 v129, v57, v221, v129
    v_fma_f32 v130, v58, v221, v130
    v_fma_f32 v131, v59, v221, v131
    v_fma_f32 v128, v200, v233, v128
    v_fma_f32 v129, v201, v233, v129
    v_fma_f32 v130, v202, v233, v130
    v_fma_f32 v131, v203, v233, v131
    v_fma_f32 v128, v80, v239, v128
    v_fma_f32 v129, v81, v239, v129
    v_fma_f32 v130, v82, v239, v130
    v_fma_f32 v131, v83, v239, v131
    v_cvt_pk_bf16_f32 v212, v116, v117
    v_cvt_pk_bf16_f32 v213, v118, v119
    v_cvt_pk_bf16_f32 v214, v128, v129
    v_cvt_pk_bf16_f32 v215, v130, v131
    s_mov_b32 s34, 131072
    buffer_store_dwordx4 v[212:215], v1, s[12:15], s34 offen sc1
    v_max3_f32 v34, v222, v228, v234
    v_max_f32 v34, v34, v240
    v_sub_f32 v222, v222, v34
    v_sub_f32 v228, v228, v34
    v_sub_f32 v234, v234, v34
    v_sub_f32 v240, v240, v34
    v_exp_f32 v222, v222
    v_exp_f32 v228, v228
    v_exp_f32 v234, v234
    v_exp_f32 v240, v240
    s_nop 0
    v_mul_f32 v34, v222, v225
    v_fma_f32 v34, v228, v231, v34
    v_fma_f32 v34, v234, v237, v34
    v_fma_f32 v34, v240, v243, v34
    v_rcp_f32 v34, v34
    s_nop 0
    v_mul_f32 v222, v222, v34
    v_mul_f32 v228, v228, v34
    v_mul_f32 v234, v234, v34
    v_mul_f32 v240, v240, v34
    v_mul_f32 v120, v120, v228
    v_mul_f32 v121, v121, v228
    v_mul_f32 v122, v122, v228
    v_mul_f32 v123, v123, v228
    v_fma_f32 v120, v48, v222, v120
    v_fma_f32 v121, v49, v222, v121
    v_fma_f32 v122, v50, v222, v122
    v_fma_f32 v123, v51, v222, v123
    v_fma_f32 v120, v192, v234, v120
    v_fma_f32 v121, v193, v234, v121
    v_fma_f32 v122, v194, v234, v122
    v_fma_f32 v123, v195, v234, v123
    v_fma_f32 v120, v72, v240, v120
    v_fma_f32 v121, v73, v240, v121
    v_fma_f32 v122, v74, v240, v122
    v_fma_f32 v123, v75, v240, v123
    v_mul_f32 v132, v132, v228
    v_mul_f32 v133, v133, v228
    v_mul_f32 v134, v134, v228
    v_mul_f32 v135, v135, v228
    v_fma_f32 v132, v60, v222, v132
    v_fma_f32 v133, v61, v222, v133
    v_fma_f32 v134, v62, v222, v134
    v_fma_f32 v135, v63, v222, v135
    v_fma_f32 v132, v204, v234, v132
    v_fma_f32 v133, v205, v234, v133
    v_fma_f32 v134, v206, v234, v134
    v_fma_f32 v135, v207, v234, v135
    v_fma_f32 v132, v84, v240, v132
    v_fma_f32 v133, v85, v240, v133
    v_fma_f32 v134, v86, v240, v134
    v_fma_f32 v135, v87, v240, v135
    v_cvt_pk_bf16_f32 v216, v120, v121
    v_cvt_pk_bf16_f32 v217, v122, v123
    v_cvt_pk_bf16_f32 v218, v132, v133
    v_cvt_pk_bf16_f32 v219, v134, v135
    s_mov_b32 s34, 262144
    buffer_store_dwordx4 v[216:219], v1, s[12:15], s34 offen sc1
    s_branch EP_END
EP_2:
    s_cmp_eq_u32 s20, 2
    s_cbranch_scc0 EP_3
    ds_write_b32 v2, v22 offset:10240
    ds_write_b32 v2, v25 offset:11008
    ds_write_b32 v2, v23 offset:10496
    ds_write_b32 v2, v26 offset:11264
    ds_write_b32 v2, v24 offset:10752
    ds_write_b32 v2, v27 offset:11520
    ds_write_b128 v1, v[160:163] offset:16384
    ds_write_b128 v1, v[164:167] offset:17408
    ds_write_b128 v1, v[168:171] offset:18432
    ds_write_b128 v1, v[172:175] offset:19456
    ds_write_b128 v1, v[176:179] offset:20480
    ds_write_b128 v1, v[180:183] offset:21504
    ds_write_b128 v1, v[88:91] offset:22528
    ds_write_b128 v1, v[92:95] offset:23552
    ds_write_b128 v1, v[96:99] offset:49152
    ds_write_b128 v1, v[100:103] offset:50176
    ds_write_b128 v1, v[104:107] offset:51200
    ds_write_b128 v1, v[108:111] offset:52224
    ds_write_b128 v1, v[112:115] offset:53248
    ds_write_b128 v1, v[116:119] offset:54272
    ds_write_b128 v1, v[120:123] offset:55296
    ds_write_b128 v1, v[124:127] offset:56320
    ds_write_b128 v3, v[128:131] offset:8192
    ds_write_b128 v3, v[132:135] offset:9216
    s_waitcnt lgkmcnt(0)
    s_barrier
    ds_read_b32 v220, v2 offset:2048
    ds_read_b32 v221, v2 offset:2304
    ds_read_b32 v222, v2 offset:2560
    ds_read_b32 v223, v2 offset:2816
    ds_read_b32 v224, v2 offset:3072
    ds_read_b32 v225, v2 offset:3328
    ds_read_b32 v226, v2 offset:6144
    ds_read_b32 v227, v2 offset:6400
    ds_read_b32 v228, v2 offset:6656
    ds_read_b32 v229, v2 offset:6912
    ds_read_b32 v230, v2 offset:7168
    ds_read_b32 v231, v2 offset:7424
    ds_read_b32 v232, v2 offset:10240
    ds_read_b32 v233, v2 offset:10496
    ds_read_b32 v234, v2 offset:10752
    ds_read_b32 v235, v2 offset:11008
    ds_read_b32 v236, v2 offset:11264
    ds_read_b32 v237, v2 offset:11520
    ds_read_b32 v238, v2 offset:14336
    ds_read_b32 v239, v2 offset:14592
    ds_read_b32 v240, v2 offset:14848
    ds_read_b32 v241, v2 offset:15104
    ds_read_b32 v242, v2 offset:15360
    ds_read_b32 v243, v2 offset:15616
    ds_read_b128 v[40:43], v1 offset:8192
    ds_read_b128 v[44:47], v1 offset:9216
    ds_read_b128 v[48:51], v1 offset:10240
    ds_read_b128 v[52:55], v1 offset:11264
    ds_read_b128 v[56:59], v1 offset:12288
    ds_read_b128 v[60:63], v1 offset:13312
    ds_read_b128 v[64:67], v1 offset:6144
    ds_read_b128 v[68:71], v1 offset:7168
    ds_read_b128 v[72:75], v1 offset:32768
    ds_read_b128 v[76:79], v1 offset:33792
    ds_read_b128 v[80:83], v1 offset:34816
    ds_read_b128 v[84:87], v1 offset:35840
    ds_read_b128 v[184:187], v1 offset:61440
    ds_read_b128 v[188:191], v1 offset:62464
    ds_read_b128 v[192:195], v1 offset:63488
    ds_read_b128 v[196:199], v1 offset:64512
    ds_read_b128 v[200:203], v3 offset:12288
    ds_read_b128 v[204:207], v3 offset:13312
    s_waitcnt lgkmcnt(0)
    v_max3_f32 v32, v220, v226, v232
    v_max_f32 v32, v32, v238
    v_sub_f32 v220, v220, v32
    v_sub_f32 v226, v226, v32
    v_sub_f32 v232, v232, v32
    v_sub_f32 v238, v238, v32
    v_exp_f32 v220, v220
    v_exp_f32 v226, v226
    v_exp_f32 v232, v232
    v_exp_f32 v238, v238
    s_nop 0
    v_mul_f32 v32, v220, v223
    v_fma_f32 v32, v226, v229, v32
    v_fma_f32 v32, v232, v235, v32
    v_fma_f32 v32, v238, v241, v32
    v_rcp_f32 v32, v32
    s_nop 0
    v_mul_f32 v220, v220, v32
    v_mul_f32 v226, v226, v32
    v_mul_f32 v232, v232, v32
    v_mul_f32 v238, v238, v32
    v_mul_f32 v136, v136, v232
    v_mul_f32 v137, v137, v232
    v_mul_f32 v138, v138, v232
    v_mul_f32 v139, v139, v232
    v_fma_f32 v136, v64, v220, v136
    v_fma_f32 v137, v65, v220, v137
    v_fma_f32 v138, v66, v220, v138
    v_fma_f32 v139, v67, v220, v139
    v_fma_f32 v136, v40, v226, v136
    v_fma_f32 v137, v41, v226, v137
    v_fma_f32 v138, v42, v226, v138
    v_fma_f32 v139, v43, v226, v139
    v_fma_f32 v136, v184, v238, v136
    v_fma_f32 v137, v185, v238, v137
    v_fma_f32 v138, v186, v238, v138
    v_fma_f32 v139, v187, v238, v139
    v_mul_f32 v148, v148, v232
    v_mul_f32 v149, v149, v232
    v_mul_f32 v150, v150, v232
    v_mul_f32 v151, v151, v232
    v_fma_f32 v148, v76, v220, v148
    v_fma_f32 v149, v77, v220, v149
    v_fma_f32 v150, v78, v220, v150
    v_fma_f32 v151, v79, v220, v151
    v_fma_f32 v148, v52, v226, v148
    v_fma_f32 v149, v53, v226, v149
    v_fma_f32 v150, v54, v226, v150
    v_fma_f32 v151, v55, v226, v151
    v_fma_f32 v148, v196, v238, v148
    v_fma_f32 v149, v197, v238, v149
    v_fma_f32 v150, v198, v238, v150
    v_fma_f32 v151, v199, v238, v151
    v_cvt_pk_bf16_f32 v208, v136, v137
    v_cvt_pk_bf16_f32 v209, v138, v139
    v_cvt_pk_bf16_f32 v210, v148, v149
    v_cvt_pk_bf16_f32 v211, v150, v151
    s_mov_b32 s34, 0
    buffer_store_dwordx4 v[208:211], v1, s[12:15], s34 offen sc1
    v_max3_f32 v33, v221, v227, v233
    v_max_f32 v33, v33, v239
    v_sub_f32 v221, v221, v33
    v_sub_f32 v227, v227, v33
    v_sub_f32 v233, v233, v33
    v_sub_f32 v239, v239, v33
    v_exp_f32 v221, v221
    v_exp_f32 v227, v227
    v_exp_f32 v233, v233
    v_exp_f32 v239, v239
    s_nop 0
    v_mul_f32 v33, v221, v224
    v_fma_f32 v33, v227, v230, v33
    v_fma_f32 v33, v233, v236, v33
    v_fma_f32 v33, v239, v242, v33
    v_rcp_f32 v33, v33
    s_nop 0
    v_mul_f32 v221, v221, v33
    v_mul_f32 v227, v227, v33
    v_mul_f32 v233, v233, v33
    v_mul_f32 v239, v239, v33
    v_mul_f32 v140, v140, v233
    v_mul_f32 v141, v141, v233
    v_mul_f32 v142, v142, v233
    v_mul_f32 v143, v143, v233
    v_fma_f32 v140, v68, v221, v140
    v_fma_f32 v141, v69, v221, v141
    v_fma_f32 v142, v70, v221, v142
    v_fma_f32 v143, v71, v221, v143
    v_fma_f32 v140, v44, v227, v140
    v_fma_f32 v141, v45, v227, v141
    v_fma_f32 v142, v46, v227, v142
    v_fma_f32 v143, v47, v227, v143
    v_fma_f32 v140, v188, v239, v140
    v_fma_f32 v141, v189, v239, v141
    v_fma_f32 v142, v190, v239, v142
    v_fma_f32 v143, v191, v239, v143
    v_mul_f32 v152, v152, v233
    v_mul_f32 v153, v153, v233
    v_mul_f32 v154, v154, v233
    v_mul_f32 v155, v155, v233
    v_fma_f32 v152, v80, v221, v152
    v_fma_f32 v153, v81, v221, v153
    v_fma_f32 v154, v82, v221, v154
    v_fma_f32 v155, v83, v221, v155
    v_fma_f32 v152, v56, v227, v152
    v_fma_f32 v153, v57, v227, v153
    v_fma_f32 v154, v58, v227, v154
    v_fma_f32 v155, v59, v227, v155
    v_fma_f32 v152, v200, v239, v152
    v_fma_f32 v153, v201, v239, v153
    v_fma_f32 v154, v202, v239, v154
    v_fma_f32 v155, v203, v239, v155
    v_cvt_pk_bf16_f32 v212, v140, v141
    v_cvt_pk_bf16_f32 v213, v142, v143
    v_cvt_pk_bf16_f32 v214, v152, v153
    v_cvt_pk_bf16_f32 v215, v154, v155
    s_mov_b32 s34, 131072
    buffer_store_dwordx4 v[212:215], v1, s[12:15], s34 offen sc1
    v_max3_f32 v34, v222, v228, v234
    v_max_f32 v34, v34, v240
    v_sub_f32 v222, v222, v34
    v_sub_f32 v228, v228, v34
    v_sub_f32 v234, v234, v34
    v_sub_f32 v240, v240, v34
    v_exp_f32 v222, v222
    v_exp_f32 v228, v228
    v_exp_f32 v234, v234
    v_exp_f32 v240, v240
    s_nop 0
    v_mul_f32 v34, v222, v225
    v_fma_f32 v34, v228, v231, v34
    v_fma_f32 v34, v234, v237, v34
    v_fma_f32 v34, v240, v243, v34
    v_rcp_f32 v34, v34
    s_nop 0
    v_mul_f32 v222, v222, v34
    v_mul_f32 v228, v228, v34
    v_mul_f32 v234, v234, v34
    v_mul_f32 v240, v240, v34
    v_mul_f32 v144, v144, v234
    v_mul_f32 v145, v145, v234
    v_mul_f32 v146, v146, v234
    v_mul_f32 v147, v147, v234
    v_fma_f32 v144, v72, v222, v144
    v_fma_f32 v145, v73, v222, v145
    v_fma_f32 v146, v74, v222, v146
    v_fma_f32 v147, v75, v222, v147
    v_fma_f32 v144, v48, v228, v144
    v_fma_f32 v145, v49, v228, v145
    v_fma_f32 v146, v50, v228, v146
    v_fma_f32 v147, v51, v228, v147
    v_fma_f32 v144, v192, v240, v144
    v_fma_f32 v145, v193, v240, v145
    v_fma_f32 v146, v194, v240, v146
    v_fma_f32 v147, v195, v240, v147
    v_mul_f32 v156, v156, v234
    v_mul_f32 v157, v157, v234
    v_mul_f32 v158, v158, v234
    v_mul_f32 v159, v159, v234
    v_fma_f32 v156, v84, v222, v156
    v_fma_f32 v157, v85, v222, v157
    v_fma_f32 v158, v86, v222, v158
    v_fma_f32 v159, v87, v222, v159
    v_fma_f32 v156, v60, v228, v156
    v_fma_f32 v157, v61, v228, v157
    v_fma_f32 v158, v62, v228, v158
    v_fma_f32 v159, v63, v228, v159
    v_fma_f32 v156, v204, v240, v156
    v_fma_f32 v157, v205, v240, v157
    v_fma_f32 v158, v206, v240, v158
    v_fma_f32 v159, v207, v240, v159
    v_cvt_pk_bf16_f32 v216, v144, v145
    v_cvt_pk_bf16_f32 v217, v146, v147
    v_cvt_pk_bf16_f32 v218, v156, v157
    v_cvt_pk_bf16_f32 v219, v158, v159
    s_mov_b32 s34, 262144
    buffer_store_dwordx4 v[216:219], v1, s[12:15], s34 offen sc1
    s_branch EP_END
EP_3:
    ds_write_b32 v2, v22 offset:14336
    ds_write_b32 v2, v25 offset:15104
    ds_write_b32 v2, v23 offset:14592
    ds_write_b32 v2, v26 offset:15360
    ds_write_b32 v2, v24 offset:14848
    ds_write_b32 v2, v27 offset:15616
    ds_write_b128 v1, v[88:91] offset:24576
    ds_write_b128 v1, v[92:95] offset:25600
    ds_write_b128 v1, v[96:99] offset:26624
    ds_write_b128 v1, v[100:103] offset:27648
    ds_write_b128 v1, v[104:107] offset:28672
    ds_write_b128 v1, v[108:111] offset:29696
    ds_write_b128 v1, v[112:115] offset:30720
    ds_write_b128 v1, v[116:119] offset:31744
    ds_write_b128 v1, v[120:123] offset:57344
    ds_write_b128 v1, v[124:127] offset:58368
    ds_write_b128 v1, v[128:131] offset:59392
    ds_write_b128 v1, v[132:135] offset:60416
    ds_write_b128 v1, v[136:139] offset:61440
    ds_write_b128 v1, v[140:143] offset:62464
    ds_write_b128 v1, v[144:147] offset:63488
    ds_write_b128 v1, v[148:151] offset:64512
    ds_write_b128 v3, v[152:155] offset:12288
    ds_write_b128 v3, v[156:159] offset:13312
    s_waitcnt lgkmcnt(0)
    s_barrier
    ds_read_b32 v220, v2 offset:2048
    ds_read_b32 v221, v2 offset:2304
    ds_read_b32 v222, v2 offset:2560
    ds_read_b32 v223, v2 offset:2816
    ds_read_b32 v224, v2 offset:3072
    ds_read_b32 v225, v2 offset:3328
    ds_read_b32 v226, v2 offset:6144
    ds_read_b32 v227, v2 offset:6400
    ds_read_b32 v228, v2 offset:6656
    ds_read_b32 v229, v2 offset:6912
    ds_read_b32 v230, v2 offset:7168
    ds_read_b32 v231, v2 offset:7424
    ds_read_b32 v232, v2 offset:10240
    ds_read_b32 v233, v2 offset:10496
    ds_read_b32 v234, v2 offset:10752
    ds_read_b32 v235, v2 offset:11008
    ds_read_b32 v236, v2 offset:11264
    ds_read_b32 v237, v2 offset:11520
    ds_read_b32 v238, v2 offset:14336
    ds_read_b32 v239, v2 offset:14592
    ds_read_b32 v240, v2 offset:14848
    ds_read_b32 v241, v2 offset:15104
    ds_read_b32 v242, v2 offset:15360
    ds_read_b32 v243, v2 offset:15616
    ds_read_b128 v[40:43], v1 offset:16384
    ds_read_b128 v[44:47], v1 offset:17408
    ds_read_b128 v[48:51], v1 offset:18432
    ds_read_b128 v[52:55], v1 offset:19456
    ds_read_b128 v[56:59], v1 offset:20480
    ds_read_b128 v[60:63], v1 offset:21504
    ds_read_b128 v[64:67], v1 offset:14336
    ds_read_b128 v[68:71], v1 offset:15360
    ds_read_b128 v[72:75], v1 offset:40960
    ds_read_b128 v[76:79], v1 offset:41984
    ds_read_b128 v[80:83], v1 offset:43008
    ds_read_b128 v[84:87], v1 offset:44032
    ds_read_b128 v[184:187], v1 offset:36864
    ds_read_b128 v[188:191], v1 offset:37888
    ds_read_b128 v[192:195], v1 offset:38912
    ds_read_b128 v[196:199], v1 offset:39936
    ds_read_b128 v[200:203], v3 offset:0
    ds_read_b128 v[204:207], v3 offset:1024
    s_waitcnt lgkmcnt(0)
    v_max3_f32 v32, v220, v226, v232
    v_max_f32 v32, v32, v238
    v_sub_f32 v220, v220, v32
    v_sub_f32 v226, v226, v32
    v_sub_f32 v232, v232, v32
    v_sub_f32 v238, v238, v32
    v_exp_f32 v220, v220
    v_exp_f32 v226, v226
    v_exp_f32 v232, v232
    v_exp_f32 v238, v238
    s_nop 0
    v_mul_f32 v32, v220, v223
    v_fma_f32 v32, v226, v229, v32
    v_fma_f32 v32, v232, v235, v32
    v_fma_f32 v32, v238, v241, v32
    v_rcp_f32 v32, v32
    s_nop 0
    v_mul_f32 v220, v220, v32
    v_mul_f32 v226, v226, v32
    v_mul_f32 v232, v232, v32
    v_mul_f32 v238, v238, v32
    v_mul_f32 v160, v160, v238
    v_mul_f32 v161, v161, v238
    v_mul_f32 v162, v162, v238
    v_mul_f32 v163, v163, v238
    v_fma_f32 v160, v184, v220, v160
    v_fma_f32 v161, v185, v220, v161
    v_fma_f32 v162, v186, v220, v162
    v_fma_f32 v163, v187, v220, v163
    v_fma_f32 v160, v64, v226, v160
    v_fma_f32 v161, v65, v226, v161
    v_fma_f32 v162, v66, v226, v162
    v_fma_f32 v163, v67, v226, v163
    v_fma_f32 v160, v40, v232, v160
    v_fma_f32 v161, v41, v232, v161
    v_fma_f32 v162, v42, v232, v162
    v_fma_f32 v163, v43, v232, v163
    v_mul_f32 v172, v172, v238
    v_mul_f32 v173, v173, v238
    v_mul_f32 v174, v174, v238
    v_mul_f32 v175, v175, v238
    v_fma_f32 v172, v196, v220, v172
    v_fma_f32 v173, v197, v220, v173
    v_fma_f32 v174, v198, v220, v174
    v_fma_f32 v175, v199, v220, v175
    v_fma_f32 v172, v76, v226, v172
    v_fma_f32 v173, v77, v226, v173
    v_fma_f32 v174, v78, v226, v174
    v_fma_f32 v175, v79, v226, v175
    v_fma_f32 v172, v52, v232, v172
    v_fma_f32 v173, v53, v232, v173
    v_fma_f32 v174, v54, v232, v174
    v_fma_f32 v175, v55, v232, v175
    v_cvt_pk_bf16_f32 v208, v160, v161
    v_cvt_pk_bf16_f32 v209, v162, v163
    v_cvt_pk_bf16_f32 v210, v172, v173
    v_cvt_pk_bf16_f32 v211, v174, v175
    s_mov_b32 s34, 0
    buffer_store_dwordx4 v[208:211], v1, s[12:15], s34 offen sc1
    v_max3_f32 v33, v221, v227, v233
    v_max_f32 v33, v33, v239
    v_sub_f32 v221, v221, v33
    v_sub_f32 v227, v227, v33
    v_sub_f32 v233, v233, v33
    v_sub_f32 v239, v239, v33
    v_exp_f32 v221, v221
    v_exp_f32 v227, v227
    v_exp_f32 v233, v233
    v_exp_f32 v239, v239
    s_nop 0
    v_mul_f32 v33, v221, v224
    v_fma_f32 v33, v227, v230, v33
    v_fma_f32 v33, v233, v236, v33
    v_fma_f32 v33, v239, v242, v33
    v_rcp_f32 v33, v33
    s_nop 0
    v_mul_f32 v221, v221, v33
    v_mul_f32 v227, v227, v33
    v_mul_f32 v233, v233, v33
    v_mul_f32 v239, v239, v33
    v_mul_f32 v164, v164, v239
    v_mul_f32 v165, v165, v239
    v_mul_f32 v166, v166, v239
    v_mul_f32 v167, v167, v239
    v_fma_f32 v164, v188, v221, v164
    v_fma_f32 v165, v189, v221, v165
    v_fma_f32 v166, v190, v221, v166
    v_fma_f32 v167, v191, v221, v167
    v_fma_f32 v164, v68, v227, v164
    v_fma_f32 v165, v69, v227, v165
    v_fma_f32 v166, v70, v227, v166
    v_fma_f32 v167, v71, v227, v167
    v_fma_f32 v164, v44, v233, v164
    v_fma_f32 v165, v45, v233, v165
    v_fma_f32 v166, v46, v233, v166
    v_fma_f32 v167, v47, v233, v167
    v_mul_f32 v176, v176, v239
    v_mul_f32 v177, v177, v239
    v_mul_f32 v178, v178, v239
    v_mul_f32 v179, v179, v239
    v_fma_f32 v176, v200, v221, v176
    v_fma_f32 v177, v201, v221, v177
    v_fma_f32 v178, v202, v221, v178
    v_fma_f32 v179, v203, v221, v179
    v_fma_f32 v176, v80, v227, v176
    v_fma_f32 v177, v81, v227, v177
    v_fma_f32 v178, v82, v227, v178
    v_fma_f32 v179, v83, v227, v179
    v_fma_f32 v176, v56, v233, v176
    v_fma_f32 v177, v57, v233, v177
    v_fma_f32 v178, v58, v233, v178
    v_fma_f32 v179, v59, v233, v179
    v_cvt_pk_bf16_f32 v212, v164, v165
    v_cvt_pk_bf16_f32 v213, v166, v167
    v_cvt_pk_bf16_f32 v214, v176, v177
    v_cvt_pk_bf16_f32 v215, v178, v179
    s_mov_b32 s34, 131072
    buffer_store_dwordx4 v[212:215], v1, s[12:15], s34 offen sc1
    v_max3_f32 v34, v222, v228, v234
    v_max_f32 v34, v34, v240
    v_sub_f32 v222, v222, v34
    v_sub_f32 v228, v228, v34
    v_sub_f32 v234, v234, v34
    v_sub_f32 v240, v240, v34
    v_exp_f32 v222, v222
    v_exp_f32 v228, v228
    v_exp_f32 v234, v234
    v_exp_f32 v240, v240
    s_nop 0
    v_mul_f32 v34, v222, v225
    v_fma_f32 v34, v228, v231, v34
    v_fma_f32 v34, v234, v237, v34
    v_fma_f32 v34, v240, v243, v34
    v_rcp_f32 v34, v34
    s_nop 0
    v_mul_f32 v222, v222, v34
    v_mul_f32 v228, v228, v34
    v_mul_f32 v234, v234, v34
    v_mul_f32 v240, v240, v34
    v_mul_f32 v168, v168, v240
    v_mul_f32 v169, v169, v240
    v_mul_f32 v170, v170, v240
    v_mul_f32 v171, v171, v240
    v_fma_f32 v168, v192, v222, v168
    v_fma_f32 v169, v193, v222, v169
    v_fma_f32 v170, v194, v222, v170
    v_fma_f32 v171, v195, v222, v171
    v_fma_f32 v168, v72, v228, v168
    v_fma_f32 v169, v73, v228, v169
    v_fma_f32 v170, v74, v228, v170
    v_fma_f32 v171, v75, v228, v171
    v_fma_f32 v168, v48, v234, v168
    v_fma_f32 v169, v49, v234, v169
    v_fma_f32 v170, v50, v234, v170
    v_fma_f32 v171, v51, v234, v171
    v_mul_f32 v180, v180, v240
    v_mul_f32 v181, v181, v240
    v_mul_f32 v182, v182, v240
    v_mul_f32 v183, v183, v240
    v_fma_f32 v180, v204, v222, v180
    v_fma_f32 v181, v205, v222, v181
    v_fma_f32 v182, v206, v222, v182
    v_fma_f32 v183, v207, v222, v183
    v_fma_f32 v180, v84, v228, v180
    v_fma_f32 v181, v85, v228, v181
    v_fma_f32 v182, v86, v228, v182
    v_fma_f32 v183, v87, v228, v183
    v_fma_f32 v180, v60, v234, v180
    v_fma_f32 v181, v61, v234, v181
    v_fma_f32 v182, v62, v234, v182
    v_fma_f32 v183, v63, v234, v183
    v_cvt_pk_bf16_f32 v216, v168, v169
    v_cvt_pk_bf16_f32 v217, v170, v171
    v_cvt_pk_bf16_f32 v218, v180, v181
    v_cvt_pk_bf16_f32 v219, v182, v183
    s_mov_b32 s34, 262144
    buffer_store_dwordx4 v[216:219], v1, s[12:15], s34 offen sc1
EP_END:
    s_waitcnt vmcnt(0)
    s_barrier
    s_cmp_lg_u32 s20, 0
    s_cbranch_scc1 OSIG_SKIP
    s_memrealtime s[56:57]
    s_lshl_b32 s54, s23, 3
    s_add_u32 s54, s54, s21
    s_lshl_b32 s55, s54, 7
    s_lshl_b32 s65, s22, 2
    s_add_u32 s55, s55, s65
    s_add_u32 s55, s55, 41943040
    s_add_u32 s12, s70, s55
    s_addc_u32 s13, s71, 0
    s_mov_b32 s14, 4
    s_mov_b32 s15, 0x20000
    s_waitcnt lgkmcnt(0)
    s_or_b32 s56, s56, 1
    s_mov_b64 exec, 1
    v_mov_b32 v248, s56
    v_mov_b32 v249, 0
    buffer_store_dword v248, v249, s[12:15], 0 offen sc1
    s_mov_b64 exec, -1
    s_lshl_b32 s54, s54, 3
    s_mov_b32 s12, s68
    s_mov_b32 s13, s69
    s_mov_b32 s14, 256
    s_mov_b32 s15, 0x20000
    s_mov_b64 exec, 1
    v_mov_b32 v248, 1
    v_mov_b32 v249, s54
    buffer_atomic_add v248, v249, s[12:15], 0 offen sc1
    s_mov_b64 exec, -1
OSIG_SKIP:
    s_cmp_eq_u32 s62, 1
    s_cbranch_scc1 PROJ
FIN:
K1_END:
    s_endpgm
PROJ:
    s_and_b32 s54, s2, 7
    s_lshr_b32 s55, s2, 3
    s_and_b32 s55, s55, 31
    s_lshr_b32 s36, s54, 2
    s_lshr_b32 s37, s54, 1
    s_and_b32 s37, s37, 1
    s_lshl_b32 s37, s37, 2
    s_lshr_b32 s38, s55, 3
    s_add_u32 s37, s37, s38
    s_and_b32 s38, s54, 1
    s_lshl_b32 s38, s38, 2
    s_lshr_b32 s39, s55, 1
    s_and_b32 s39, s39, 3
    s_add_u32 s38, s38, s39
    s_and_b32 s39, s55, 1
    s_and_b32 s54, s37, 3
    s_lshl_b32 s54, s54, 2
    s_and_b32 s55, s38, 3
    s_add_u32 s26, s54, s55
    s_cmp_eq_u32 s36, 1
    s_cselect_b64 s[72:73], s[74:75], s[72:73]
    s_lshl_b32 s54, s39, 2
    s_add_u32 s54, s54, s20
    s_lshl_b32 s27, s54, 14
    s_lshl_b32 s54, s54, 19
    s_lshl_b32 s55, s38, 7
    s_add_u32 s54, s54, s55
    s_add_u32 s4, s72, s54
    s_addc_u32 s5, s73, 0
    s_sub_u32 s6, 4194304, s54
    s_mov_b32 s7, 0x20000
    s_lshl_b32 s54, s36, 3
    s_add_u32 s54, s54, s37
    s_lshl_b32 s29, s54, 3
    s_mul_i32 s54, s54, 393216
    s_add_u32 s54, s54, s27
    s_add_u32 s8, s70, s54
    s_addc_u32 s9, s71, 0
    s_mov_b32 s10, 278528
    s_mov_b32 s11, 0x20000
    s_mov_b32 s12, s68
    s_mov_b32 s13, s69
    s_mov_b32 s14, 256
    s_mov_b32 s15, 0x20000
    v_lshlrev_b32 v4, 4, v0
    v_mov_b32 v6, v253
    v_mov_b32 v7, v254
    v_lshrrev_b32 v1, 4, v0
    v_and_b32 v1, 3, v1
    v_lshlrev_b32 v1, 1, v1
    v_and_b32 v2, 7, v0
    v_xor_b32 v1, v1, v2
    v_lshlrev_b32 v1, 4, v1
    v_lshrrev_b32 v5, 3, v0
    v_lshl_add_u32 v5, v5, 10, v1
    v_lshrrev_b32 v1, 2, v0
    v_lshrrev_b32 v2, 1, v1
    v_and_b32 v2, 3, v2
    v_lshlrev_b32 v2, 5, v2
    v_lshl_add_u32 v2, v1, 7, v2
    v_and_b32 v1, 3, v0
    v_lshl_add_u32 v2, v1, 3, v2
    s_lshl_b32 s58, s20, 13
    v_add_u32 v244, s58, v2
    v_xor_b32 v245, 32, v244
    v_xor_b32 v246, 64, v244
    v_xor_b32 v247, 96, v244
    s_lshl_b32 s24, s26, 15
    s_add_u32 m0, s58, 0
    s_add_u32 s25, s24, 0
    buffer_load_dwordx4 v5, s[4:7], s25 offen lds
    s_add_u32 m0, s58, 1024
    s_add_u32 s25, s24, 8192
    buffer_load_dwordx4 v5, s[4:7], s25 offen lds
    s_add_u32 m0, s58, 2048
    s_add_u32 s25, s24, 16384
    buffer_load_dwordx4 v5, s[4:7], s25 offen lds
    s_add_u32 m0, s58, 3072
    s_add_u32 s25, s24, 24576
    buffer_load_dwordx4 v5, s[4:7], s25 offen lds
    s_add_u32 s24, s24, 0x8000
    s_and_b32 s24, s24, 0x7ffff
    s_add_u32 m0, s58, 4096
    s_add_u32 s25, s24, 0
    buffer_load_dwordx4 v5, s[4:7], s25 offen lds
    s_add_u32 m0, s58, 5120
    s_add_u32 s25, s24, 8192
    buffer_load_dwordx4 v5, s[4:7], s25 offen lds
    s_add_u32 m0, s58, 6144
    s_add_u32 s25, s24, 16384
    buffer_load_dwordx4 v5, s[4:7], s25 offen lds
    s_add_u32 m0, s58, 7168
    s_add_u32 s25, s24, 24576
    buffer_load_dwordx4 v5, s[4:7], s25 offen lds
    s_add_u32 s24, s24, 0x8000
    s_and_b32 s24, s24, 0x7ffff
    s_add_u32 m0, s58, 32768
    s_add_u32 s25, s24, 0
    buffer_load_dwordx4 v5, s[4:7], s25 offen lds
    s_add_u32 m0, s58, 33792
    s_add_u32 s25, s24, 8192
    buffer_load_dwordx4 v5, s[4:7], s25 offen lds
    s_add_u32 m0, s58, 34816
    s_add_u32 s25, s24, 16384
    buffer_load_dwordx4 v5, s[4:7], s25 offen lds
    s_add_u32 m0, s58, 35840
    s_add_u32 s25, s24, 24576
    buffer_load_dwordx4 v5, s[4:7], s25 offen lds
    s_add_u32 s24, s24, 0x8000
    s_and_b32 s24, s24, 0x7ffff
    s_add_u32 m0, s58, 36864
    s_add_u32 s25, s24, 0
    buffer_load_dwordx4 v5, s[4:7], s25 offen lds
    s_add_u32 m0, s58, 37888
    s_add_u32 s25, s24, 8192
    buffer_load_dwordx4 v5, s[4:7], s25 offen lds
    s_add_u32 m0, s58, 38912
    s_add_u32 s25, s24, 16384
    buffer_load_dwordx4 v5, s[4:7], s25 offen lds
    s_add_u32 m0, s58, 39936
    s_add_u32 s25, s24, 24576
    buffer_load_dwordx4 v5, s[4:7], s25 offen lds
    s_add_u32 s24, s24, 0x8000
    s_and_b32 s24, s24, 0x7ffff
    s_waitcnt vmcnt(12)
    ds_read_b64_tr_b16 v[56:57], v244 offset:0
    ds_read_b64_tr_b16 v[58:59], v244 offset:2048
    ds_read_b64_tr_b16 v[60:61], v245 offset:0
    ds_read_b64_tr_b16 v[62:63], v245 offset:2048
    ds_read_b64_tr_b16 v[64:65], v246 offset:0
    ds_read_b64_tr_b16 v[66:67], v246 offset:2048
    ds_read_b64_tr_b16 v[68:69], v247 offset:0
    ds_read_b64_tr_b16 v[70:71], v247 offset:2048
    s_waitcnt lgkmcnt(0)
    s_add_u32 m0, s58, 0
    s_add_u32 s25, s24, 0
    buffer_load_dwordx4 v5, s[4:7], s25 offen lds
    s_add_u32 m0, s58, 1024
    s_add_u32 s25, s24, 8192
    buffer_load_dwordx4 v5, s[4:7], s25 offen lds
    s_add_u32 m0, s58, 2048
    s_add_u32 s25, s24, 16384
    buffer_load_dwordx4 v5, s[4:7], s25 offen lds
    s_add_u32 m0, s58, 3072
    s_add_u32 s25, s24, 24576
    buffer_load_dwordx4 v5, s[4:7], s25 offen lds
    s_add_u32 s24, s24, 0x8000
    s_and_b32 s24, s24, 0x7ffff
    s_waitcnt vmcnt(12)
    ds_read_b64_tr_b16 v[72:73], v244 offset:4096
    ds_read_b64_tr_b16 v[74:75], v244 offset:6144
    ds_read_b64_tr_b16 v[76:77], v245 offset:4096
    ds_read_b64_tr_b16 v[78:79], v245 offset:6144
    ds_read_b64_tr_b16 v[80:81], v246 offset:4096
    ds_read_b64_tr_b16 v[82:83], v246 offset:6144
    ds_read_b64_tr_b16 v[84:85], v247 offset:4096
    ds_read_b64_tr_b16 v[86:87], v247 offset:6144
    s_waitcnt lgkmcnt(0)
    s_add_u32 m0, s58, 4096
    s_add_u32 s25, s24, 0
    buffer_load_dwordx4 v5, s[4:7], s25 offen lds
    s_add_u32 m0, s58, 5120
    s_add_u32 s25, s24, 8192
    buffer_load_dwordx4 v5, s[4:7], s25 offen lds
    s_add_u32 m0, s58, 6144
    s_add_u32 s25, s24, 16384
    buffer_load_dwordx4 v5, s[4:7], s25 offen lds
    s_add_u32 m0, s58, 7168
    s_add_u32 s25, s24, 24576
    buffer_load_dwordx4 v5, s[4:7], s25 offen lds
    s_add_u32 s24, s24, 0x8000
    s_and_b32 s24, s24, 0x7ffff
    s_waitcnt vmcnt(12)
    ds_read_b64_tr_b16 v[88:89], v244 offset:32768
    ds_read_b64_tr_b16 v[90:91], v244 offset:34816
    ds_read_b64_tr_b16 v[92:93], v245 offset:32768
    ds_read_b64_tr_b16 v[94:95], v245 offset:34816
    ds_read_b64_tr_b16 v[96:97], v246 offset:32768
    ds_read_b64_tr_b16 v[98:99], v246 offset:34816
    ds_read_b64_tr_b16 v[100:101], v247 offset:32768
    ds_read_b64_tr_b16 v[102:103], v247 offset:34816
    s_waitcnt lgkmcnt(0)
    s_add_u32 m0, s58, 32768
    s_add_u32 s25, s24, 0
    buffer_load_dwordx4 v5, s[4:7], s25 offen lds
    s_add_u32 m0, s58, 33792
    s_add_u32 s25, s24, 8192
    buffer_load_dwordx4 v5, s[4:7], s25 offen lds
    s_add_u32 m0, s58, 34816
    s_add_u32 s25, s24, 16384
    buffer_load_dwordx4 v5, s[4:7], s25 offen lds
    s_add_u32 m0, s58, 35840
    s_add_u32 s25, s24, 24576
    buffer_load_dwordx4 v5, s[4:7], s25 offen lds
    s_add_u32 s24, s24, 0x8000
    s_and_b32 s24, s24, 0x7ffff
    s_waitcnt vmcnt(12)
    ds_read_b64_tr_b16 v[104:105], v244 offset:36864
    ds_read_b64_tr_b16 v[106:107], v244 offset:38912
    ds_read_b64_tr_b16 v[108:109], v245 offset:36864
    ds_read_b64_tr_b16 v[110:111], v245 offset:38912
    ds_read_b64_tr_b16 v[112:113], v246 offset:36864
    ds_read_b64_tr_b16 v[114:115], v246 offset:38912
    ds_read_b64_tr_b16 v[116:117], v247 offset:36864
    ds_read_b64_tr_b16 v[118:119], v247 offset:38912
    s_waitcnt lgkmcnt(0)
    s_add_u32 m0, s58, 36864
    s_add_u32 s25, s24, 0
    buffer_load_dwordx4 v5, s[4:7], s25 offen lds
    s_add_u32 m0, s58, 37888
    s_add_u32 s25, s24, 8192
    buffer_load_dwordx4 v5, s[4:7], s25 offen lds
    s_add_u32 m0, s58, 38912
    s_add_u32 s25, s24, 16384
    buffer_load_dwordx4 v5, s[4:7], s25 offen lds
    s_add_u32 m0, s58, 39936
    s_add_u32 s25, s24, 24576
    buffer_load_dwordx4 v5, s[4:7], s25 offen lds
    s_add_u32 s24, s24, 0x8000
    s_and_b32 s24, s24, 0x7ffff
    s_waitcnt vmcnt(12)
    ds_read_b64_tr_b16 v[120:121], v244 offset:0
    ds_read_b64_tr_b16 v[122:123], v244 offset:2048
    ds_read_b64_tr_b16 v[124:125], v245 offset:0
    ds_read_b64_tr_b16 v[126:127], v245 offset:2048
    ds_read_b64_tr_b16 v[128:129], v246 offset:0
    ds_read_b64_tr_b16 v[130:131], v246 offset:2048
    ds_read_b64_tr_b16 v[132:133], v247 offset:0
    ds_read_b64_tr_b16 v[134:135], v247 offset:2048
    s_waitcnt lgkmcnt(0)
    s_add_u32 m0, s58, 0
    s_add_u32 s25, s24, 0
    buffer_load_dwordx4 v5, s[4:7], s25 offen lds
    s_add_u32 m0, s58, 1024
    s_add_u32 s25, s24, 8192
    buffer_load_dwordx4 v5, s[4:7], s25 offen lds
    s_add_u32 m0, s58, 2048
    s_add_u32 s25, s24, 16384
    buffer_load_dwordx4 v5, s[4:7], s25 offen lds
    s_add_u32 m0, s58, 3072
    s_add_u32 s25, s24, 24576
    buffer_load_dwordx4 v5, s[4:7], s25 offen lds
    s_add_u32 s24, s24, 0x8000
    s_and_b32 s24, s24, 0x7ffff
    s_waitcnt vmcnt(12)
    ds_read_b64_tr_b16 v[136:137], v244 offset:4096
    ds_read_b64_tr_b16 v[138:139], v244 offset:6144
    ds_read_b64_tr_b16 v[140:141], v245 offset:4096
    ds_read_b64_tr_b16 v[142:143], v245 offset:6144
    ds_read_b64_tr_b16 v[144:145], v246 offset:4096
    ds_read_b64_tr_b16 v[146:147], v246 offset:6144
    ds_read_b64_tr_b16 v[148:149], v247 offset:4096
    ds_read_b64_tr_b16 v[150:151], v247 offset:6144
    s_waitcnt lgkmcnt(0)
    s_add_u32 m0, s58, 4096
    s_add_u32 s25, s24, 0
    buffer_load_dwordx4 v5, s[4:7], s25 offen lds
    s_add_u32 m0, s58, 5120
    s_add_u32 s25, s24, 8192
    buffer_load_dwordx4 v5, s[4:7], s25 offen lds
    s_add_u32 m0, s58, 6144
    s_add_u32 s25, s24, 16384
    buffer_load_dwordx4 v5, s[4:7], s25 offen lds
    s_add_u32 m0, s58, 7168
    s_add_u32 s25, s24, 24576
    buffer_load_dwordx4 v5, s[4:7], s25 offen lds
    s_add_u32 s24, s24, 0x8000
    s_and_b32 s24, s24, 0x7ffff
    s_waitcnt vmcnt(12)
    ds_read_b64_tr_b16 v[152:153], v244 offset:32768
    ds_read_b64_tr_b16 v[154:155], v244 offset:34816
    ds_read_b64_tr_b16 v[156:157], v245 offset:32768
    ds_read_b64_tr_b16 v[158:159], v245 offset:34816
    ds_read_b64_tr_b16 v[160:161], v246 offset:32768
    ds_read_b64_tr_b16 v[162:163], v246 offset:34816
    ds_read_b64_tr_b16 v[164:165], v247 offset:32768
    ds_read_b64_tr_b16 v[166:167], v247 offset:34816
    s_waitcnt lgkmcnt(0)
    s_add_u32 m0, s58, 32768
    s_add_u32 s25, s24, 0
    buffer_load_dwordx4 v5, s[4:7], s25 offen lds
    s_add_u32 m0, s58, 33792
    s_add_u32 s25, s24, 8192
    buffer_load_dwordx4 v5, s[4:7], s25 offen lds
    s_add_u32 m0, s58, 34816
    s_add_u32 s25, s24, 16384
    buffer_load_dwordx4 v5, s[4:7], s25 offen lds
    s_add_u32 m0, s58, 35840
    s_add_u32 s25, s24, 24576
    buffer_load_dwordx4 v5, s[4:7], s25 offen lds
    s_add_u32 s24, s24, 0x8000
    s_and_b32 s24, s24, 0x7ffff
    s_cmp_lg_u32 s20, 0
    s_cbranch_scc1 PO_D
    s_lshl_b32 s56, s36, 3
    s_add_u32 s56, s56, s37
    s_lshl_b32 s56, s56, 7
    s_lshl_b32 s54, s39, 6
    s_add_u32 s57, s56, s54
    s_add_u32 s57, s57, 41943040
    s_add_u32 s16, s70, s57
    s_addc_u32 s17, s71, 0
    s_mov_b32 s18, 64
    s_mov_b32 s19, 0x20000
    v_lshlrev_b32 v248, 2, v0
    v_mov_b32 v250, s29
    s_mov_b32 s56, 0x3ffff
    s_mov_b32 exec_lo, 65535
    s_mov_b32 exec_hi, 0
PO_L:
    buffer_load_dword v249, v248, s[16:19], 0 offen sc1
    s_waitcnt vmcnt(0)
    v_cmp_eq_u32 vcc, v249, v6
    s_cbranch_vccz PO_E
    s_and_b32 s57, s56, 63
    s_cmp_lg_u32 s57, 0
    s_cbranch_scc1 PO_S
    buffer_load_dword v249, v250, s[12:15], 0 offen sc1
    s_waitcnt vmcnt(0)
    v_cmp_ne_u32 vcc, 32, v249
    s_cbranch_vccz PO_E
PO_S:
    s_sleep 4
    s_sub_u32 s56, s56, 1
    s_cmp_lg_u32 s56, 0
    s_cbranch_scc1 PO_L
PO_E:
    s_mov_b64 exec, -1
PO_D:
    s_barrier
    s_lshl_b32 s28, s26, 10
    buffer_load_dwordx4 v[168:171], v4, s[8:11], s28 offen sc1
    s_add_u32 s25, s28, 0x20000
    buffer_load_dwordx4 v[172:175], v4, s[8:11], s25 offen sc1
    s_add_u32 s25, s28, 0x40000
    buffer_load_dwordx4 v[176:179], v4, s[8:11], s25 offen sc1
    s_add_u32 s28, s28, 0x400
    s_and_b32 s28, s28, 0x3fff
    buffer_load_dwordx4 v[180:183], v4, s[8:11], s28 offen sc1
    s_add_u32 s25, s28, 0x20000
    buffer_load_dwordx4 v[184:187], v4, s[8:11], s25 offen sc1
    s_add_u32 s25, s28, 0x40000
    buffer_load_dwordx4 v[188:191], v4, s[8:11], s25 offen sc1
    s_add_u32 s28, s28, 0x400
    s_and_b32 s28, s28, 0x3fff
    buffer_load_dwordx4 v[192:195], v4, s[8:11], s28 offen sc1
    s_add_u32 s25, s28, 0x20000
    buffer_load_dwordx4 v[196:199], v4, s[8:11], s25 offen sc1
    s_add_u32 s25, s28, 0x40000
    buffer_load_dwordx4 v[200:203], v4, s[8:11], s25 offen sc1
    s_add_u32 s28, s28, 0x400
    s_and_b32 s28, s28, 0x3fff
    buffer_load_dwordx4 v[204:207], v4, s[8:11], s28 offen sc1
    s_add_u32 s25, s28, 0x20000
    buffer_load_dwordx4 v[208:211], v4, s[8:11], s25 offen sc1
    s_add_u32 s25, s28, 0x40000
    buffer_load_dwordx4 v[212:215], v4, s[8:11], s25 offen sc1
    s_add_u32 s28, s28, 0x400
    s_and_b32 s28, s28, 0x3fff
    buffer_load_dwordx4 v[216:219], v4, s[8:11], s28 offen sc1
    s_add_u32 s25, s28, 0x20000
    buffer_load_dwordx4 v[220:223], v4, s[8:11], s25 offen sc1
    s_add_u32 s25, s28, 0x40000
    buffer_load_dwordx4 v[224:227], v4, s[8:11], s25 offen sc1
    s_add_u32 s28, s28, 0x400
    s_and_b32 s28, s28, 0x3fff
    s_waitcnt vmcnt(12)
    v_mfma_f32_16x16x32_bf16 v[8:11], v[56:59], v[168:171], 0
    v_mfma_f32_16x16x32_bf16 v[12:15], v[56:59], v[172:175], 0
    v_mfma_f32_16x16x32_bf16 v[16:19], v[56:59], v[176:179], 0
    v_mfma_f32_16x16x32_bf16 v[20:23], v[60:63], v[168:171], 0
    v_mfma_f32_16x16x32_bf16 v[24:27], v[60:63], v[172:175], 0
    v_mfma_f32_16x16x32_bf16 v[28:31], v[60:63], v[176:179], 0
    v_mfma_f32_16x16x32_bf16 v[32:35], v[64:67], v[168:171], 0
    v_mfma_f32_16x16x32_bf16 v[36:39], v[64:67], v[172:175], 0
    v_mfma_f32_16x16x32_bf16 v[40:43], v[64:67], v[176:179], 0
    v_mfma_f32_16x16x32_bf16 v[44:47], v[68:71], v[168:171], 0
    v_mfma_f32_16x16x32_bf16 v[48:51], v[68:71], v[172:175], 0
    v_mfma_f32_16x16x32_bf16 v[52:55], v[68:71], v[176:179], 0
    buffer_load_dwordx4 v[168:171], v4, s[8:11], s28 offen sc1
    s_add_u32 s25, s28, 0x20000
    buffer_load_dwordx4 v[172:175], v4, s[8:11], s25 offen sc1
    s_add_u32 s25, s28, 0x40000
    buffer_load_dwordx4 v[176:179], v4, s[8:11], s25 offen sc1
    s_add_u32 s28, s28, 0x400
    s_and_b32 s28, s28, 0x3fff
    s_waitcnt vmcnt(12)
    v_mfma_f32_16x16x32_bf16 v[8:11], v[72:75], v[180:183], v[8:11]
    v_mfma_f32_16x16x32_bf16 v[12:15], v[72:75], v[184:187], v[12:15]
    v_mfma_f32_16x16x32_bf16 v[16:19], v[72:75], v[188:191], v[16:19]
    v_mfma_f32_16x16x32_bf16 v[20:23], v[76:79], v[180:183], v[20:23]
    v_mfma_f32_16x16x32_bf16 v[24:27], v[76:79], v[184:187], v[24:27]
    v_mfma_f32_16x16x32_bf16 v[28:31], v[76:79], v[188:191], v[28:31]
    v_mfma_f32_16x16x32_bf16 v[32:35], v[80:83], v[180:183], v[32:35]
    v_mfma_f32_16x16x32_bf16 v[36:39], v[80:83], v[184:187], v[36:39]
    v_mfma_f32_16x16x32_bf16 v[40:43], v[80:83], v[188:191], v[40:43]
    v_mfma_f32_16x16x32_bf16 v[44:47], v[84:87], v[180:183], v[44:47]
    v_mfma_f32_16x16x32_bf16 v[48:51], v[84:87], v[184:187], v[48:51]
    v_mfma_f32_16x16x32_bf16 v[52:55], v[84:87], v[188:191], v[52:55]
    buffer_load_dwordx4 v[180:183], v4, s[8:11], s28 offen sc1
    s_add_u32 s25, s28, 0x20000
    buffer_load_dwordx4 v[184:187], v4, s[8:11], s25 offen sc1
    s_add_u32 s25, s28, 0x40000
    buffer_load_dwordx4 v[188:191], v4, s[8:11], s25 offen sc1
    s_add_u32 s28, s28, 0x400
    s_and_b32 s28, s28, 0x3fff
    s_waitcnt vmcnt(12)
    v_mfma_f32_16x16x32_bf16 v[8:11], v[88:91], v[192:195], v[8:11]
    v_mfma_f32_16x16x32_bf16 v[12:15], v[88:91], v[196:199], v[12:15]
    v_mfma_f32_16x16x32_bf16 v[16:19], v[88:91], v[200:203], v[16:19]
    v_mfma_f32_16x16x32_bf16 v[20:23], v[92:95], v[192:195], v[20:23]
    v_mfma_f32_16x16x32_bf16 v[24:27], v[92:95], v[196:199], v[24:27]
    v_mfma_f32_16x16x32_bf16 v[28:31], v[92:95], v[200:203], v[28:31]
    v_mfma_f32_16x16x32_bf16 v[32:35], v[96:99], v[192:195], v[32:35]
    v_mfma_f32_16x16x32_bf16 v[36:39], v[96:99], v[196:199], v[36:39]
    v_mfma_f32_16x16x32_bf16 v[40:43], v[96:99], v[200:203], v[40:43]
    v_mfma_f32_16x16x32_bf16 v[44:47], v[100:103], v[192:195], v[44:47]
    v_mfma_f32_16x16x32_bf16 v[48:51], v[100:103], v[196:199], v[48:51]
    v_mfma_f32_16x16x32_bf16 v[52:55], v[100:103], v[200:203], v[52:55]
    buffer_load_dwordx4 v[192:195], v4, s[8:11], s28 offen sc1
    s_add_u32 s25, s28, 0x20000
    buffer_load_dwordx4 v[196:199], v4, s[8:11], s25 offen sc1
    s_add_u32 s25, s28, 0x40000
    buffer_load_dwordx4 v[200:203], v4, s[8:11], s25 offen sc1
    s_add_u32 s28, s28, 0x400
    s_and_b32 s28, s28, 0x3fff
    s_waitcnt vmcnt(12)
    v_mfma_f32_16x16x32_bf16 v[8:11], v[104:107], v[204:207], v[8:11]
    v_mfma_f32_16x16x32_bf16 v[12:15], v[104:107], v[208:211], v[12:15]
    v_mfma_f32_16x16x32_bf16 v[16:19], v[104:107], v[212:215], v[16:19]
    v_mfma_f32_16x16x32_bf16 v[20:23], v[108:111], v[204:207], v[20:23]
    v_mfma_f32_16x16x32_bf16 v[24:27], v[108:111], v[208:211], v[24:27]
    v_mfma_f32_16x16x32_bf16 v[28:31], v[108:111], v[212:215], v[28:31]
    v_mfma_f32_16x16x32_bf16 v[32:35], v[112:115], v[204:207], v[32:35]
    v_mfma_f32_16x16x32_bf16 v[36:39], v[112:115], v[208:211], v[36:39]
    v_mfma_f32_16x16x32_bf16 v[40:43], v[112:115], v[212:215], v[40:43]
    v_mfma_f32_16x16x32_bf16 v[44:47], v[116:119], v[204:207], v[44:47]
    v_mfma_f32_16x16x32_bf16 v[48:51], v[116:119], v[208:211], v[48:51]
    v_mfma_f32_16x16x32_bf16 v[52:55], v[116:119], v[212:215], v[52:55]
    buffer_load_dwordx4 v[204:207], v4, s[8:11], s28 offen sc1
    s_add_u32 s25, s28, 0x20000
    buffer_load_dwordx4 v[208:211], v4, s[8:11], s25 offen sc1
    s_add_u32 s25, s28, 0x40000
    buffer_load_dwordx4 v[212:215], v4, s[8:11], s25 offen sc1
    s_add_u32 s28, s28, 0x400
    s_and_b32 s28, s28, 0x3fff
    s_waitcnt vmcnt(12)
    v_mfma_f32_16x16x32_bf16 v[8:11], v[120:123], v[216:219], v[8:11]
    v_mfma_f32_16x16x32_bf16 v[12:15], v[120:123], v[220:223], v[12:15]
    v_mfma_f32_16x16x32_bf16 v[16:19], v[120:123], v[224:227], v[16:19]
    v_mfma_f32_16x16x32_bf16 v[20:23], v[124:127], v[216:219], v[20:23]
    v_mfma_f32_16x16x32_bf16 v[24:27], v[124:127], v[220:223], v[24:27]
    v_mfma_f32_16x16x32_bf16 v[28:31], v[124:127], v[224:227], v[28:31]
    v_mfma_f32_16x16x32_bf16 v[32:35], v[128:131], v[216:219], v[32:35]
    v_mfma_f32_16x16x32_bf16 v[36:39], v[128:131], v[220:223], v[36:39]
    v_mfma_f32_16x16x32_bf16 v[40:43], v[128:131], v[224:227], v[40:43]
    v_mfma_f32_16x16x32_bf16 v[44:47], v[132:135], v[216:219], v[44:47]
    v_mfma_f32_16x16x32_bf16 v[48:51], v[132:135], v[220:223], v[48:51]
    v_mfma_f32_16x16x32_bf16 v[52:55], v[132:135], v[224:227], v[52:55]
    buffer_load_dwordx4 v[216:219], v4, s[8:11], s28 offen sc1
    s_add_u32 s25, s28, 0x20000
    buffer_load_dwordx4 v[220:223], v4, s[8:11], s25 offen sc1
    s_add_u32 s25, s28, 0x40000
    buffer_load_dwordx4 v[224:227], v4, s[8:11], s25 offen sc1
    s_add_u32 s28, s28, 0x400
    s_and_b32 s28, s28, 0x3fff
    s_waitcnt vmcnt(12)
    v_mfma_f32_16x16x32_bf16 v[8:11], v[136:139], v[168:171], v[8:11]
    v_mfma_f32_16x16x32_bf16 v[12:15], v[136:139], v[172:175], v[12:15]
    v_mfma_f32_16x16x32_bf16 v[16:19], v[136:139], v[176:179], v[16:19]
    v_mfma_f32_16x16x32_bf16 v[20:23], v[140:143], v[168:171], v[20:23]
    v_mfma_f32_16x16x32_bf16 v[24:27], v[140:143], v[172:175], v[24:27]
    v_mfma_f32_16x16x32_bf16 v[28:31], v[140:143], v[176:179], v[28:31]
    v_mfma_f32_16x16x32_bf16 v[32:35], v[144:147], v[168:171], v[32:35]
    v_mfma_f32_16x16x32_bf16 v[36:39], v[144:147], v[172:175], v[36:39]
    v_mfma_f32_16x16x32_bf16 v[40:43], v[144:147], v[176:179], v[40:43]
    v_mfma_f32_16x16x32_bf16 v[44:47], v[148:151], v[168:171], v[44:47]
    v_mfma_f32_16x16x32_bf16 v[48:51], v[148:151], v[172:175], v[48:51]
    v_mfma_f32_16x16x32_bf16 v[52:55], v[148:151], v[176:179], v[52:55]
    buffer_load_dwordx4 v[168:171], v4, s[8:11], s28 offen sc1
    s_add_u32 s25, s28, 0x20000
    buffer_load_dwordx4 v[172:175], v4, s[8:11], s25 offen sc1
    s_add_u32 s25, s28, 0x40000
    buffer_load_dwordx4 v[176:179], v4, s[8:11], s25 offen sc1
    s_add_u32 s28, s28, 0x400
    s_and_b32 s28, s28, 0x3fff
    s_waitcnt vmcnt(12)
    v_mfma_f32_16x16x32_bf16 v[8:11], v[152:155], v[180:183], v[8:11]
    v_mfma_f32_16x16x32_bf16 v[12:15], v[152:155], v[184:187], v[12:15]
    v_mfma_f32_16x16x32_bf16 v[16:19], v[152:155], v[188:191], v[16:19]
    v_mfma_f32_16x16x32_bf16 v[20:23], v[156:159], v[180:183], v[20:23]
    v_mfma_f32_16x16x32_bf16 v[24:27], v[156:159], v[184:187], v[24:27]
    v_mfma_f32_16x16x32_bf16 v[28:31], v[156:159], v[188:191], v[28:31]
    v_mfma_f32_16x16x32_bf16 v[32:35], v[160:163], v[180:183], v[32:35]
    v_mfma_f32_16x16x32_bf16 v[36:39], v[160:163], v[184:187], v[36:39]
    v_mfma_f32_16x16x32_bf16 v[40:43], v[160:163], v[188:191], v[40:43]
    v_mfma_f32_16x16x32_bf16 v[44:47], v[164:167], v[180:183], v[44:47]
    v_mfma_f32_16x16x32_bf16 v[48:51], v[164:167], v[184:187], v[48:51]
    v_mfma_f32_16x16x32_bf16 v[52:55], v[164:167], v[188:191], v[52:55]
    buffer_load_dwordx4 v[180:183], v4, s[8:11], s28 offen sc1
    s_add_u32 s25, s28, 0x20000
    buffer_load_dwordx4 v[184:187], v4, s[8:11], s25 offen sc1
    s_add_u32 s25, s28, 0x40000
    buffer_load_dwordx4 v[188:191], v4, s[8:11], s25 offen sc1
    s_add_u32 s28, s28, 0x400
    s_and_b32 s28, s28, 0x3fff
    s_waitcnt vmcnt(48)
    ds_read_b64_tr_b16 v[228:229], v244 offset:36864
    ds_read_b64_tr_b16 v[230:231], v244 offset:38912
    ds_read_b64_tr_b16 v[232:233], v245 offset:36864
    ds_read_b64_tr_b16 v[234:235], v245 offset:38912
    ds_read_b64_tr_b16 v[236:237], v246 offset:36864
    ds_read_b64_tr_b16 v[238:239], v246 offset:38912
    ds_read_b64_tr_b16 v[240:241], v247 offset:36864
    ds_read_b64_tr_b16 v[242:243], v247 offset:38912
    s_waitcnt vmcnt(12)
    s_waitcnt lgkmcnt(0)
    v_mfma_f32_16x16x32_bf16 v[8:11], v[228:231], v[192:195], v[8:11]
    v_mfma_f32_16x16x32_bf16 v[12:15], v[228:231], v[196:199], v[12:15]
    v_mfma_f32_16x16x32_bf16 v[16:19], v[228:231], v[200:203], v[16:19]
    v_mfma_f32_16x16x32_bf16 v[20:23], v[232:235], v[192:195], v[20:23]
    v_mfma_f32_16x16x32_bf16 v[24:27], v[232:235], v[196:199], v[24:27]
    v_mfma_f32_16x16x32_bf16 v[28:31], v[232:235], v[200:203], v[28:31]
    v_mfma_f32_16x16x32_bf16 v[32:35], v[236:239], v[192:195], v[32:35]
    v_mfma_f32_16x16x32_bf16 v[36:39], v[236:239], v[196:199], v[36:39]
    v_mfma_f32_16x16x32_bf16 v[40:43], v[236:239], v[200:203], v[40:43]
    v_mfma_f32_16x16x32_bf16 v[44:47], v[240:243], v[192:195], v[44:47]
    v_mfma_f32_16x16x32_bf16 v[48:51], v[240:243], v[196:199], v[48:51]
    v_mfma_f32_16x16x32_bf16 v[52:55], v[240:243], v[200:203], v[52:55]
    buffer_load_dwordx4 v[192:195], v4, s[8:11], s28 offen sc1
    s_add_u32 s25, s28, 0x20000
    buffer_load_dwordx4 v[196:199], v4, s[8:11], s25 offen sc1
    s_add_u32 s25, s28, 0x40000
    buffer_load_dwordx4 v[200:203], v4, s[8:11], s25 offen sc1
    s_add_u32 s28, s28, 0x400
    s_and_b32 s28, s28, 0x3fff
    s_add_u32 m0, s58, 36864
    s_add_u32 s25, s24, 0
    buffer_load_dwordx4 v5, s[4:7], s25 offen lds
    s_add_u32 m0, s58, 37888
    s_add_u32 s25, s24, 8192
    buffer_load_dwordx4 v5, s[4:7], s25 offen lds
    s_add_u32 m0, s58, 38912
    s_add_u32 s25, s24, 16384
    buffer_load_dwordx4 v5, s[4:7], s25 offen lds
    s_add_u32 m0, s58, 39936
    s_add_u32 s25, s24, 24576
    buffer_load_dwordx4 v5, s[4:7], s25 offen lds
    s_add_u32 s24, s24, 0x8000
    s_and_b32 s24, s24, 0x7ffff
    s_waitcnt vmcnt(51)
    ds_read_b64_tr_b16 v[228:229], v244 offset:0
    ds_read_b64_tr_b16 v[230:231], v244 offset:2048
    ds_read_b64_tr_b16 v[232:233], v245 offset:0
    ds_read_b64_tr_b16 v[234:235], v245 offset:2048
    ds_read_b64_tr_b16 v[236:237], v246 offset:0
    ds_read_b64_tr_b16 v[238:239], v246 offset:2048
    ds_read_b64_tr_b16 v[240:241], v247 offset:0
    ds_read_b64_tr_b16 v[242:243], v247 offset:2048
    s_waitcnt vmcnt(16)
    s_waitcnt lgkmcnt(0)
    v_mfma_f32_16x16x32_bf16 v[8:11], v[228:231], v[204:207], v[8:11]
    v_mfma_f32_16x16x32_bf16 v[12:15], v[228:231], v[208:211], v[12:15]
    v_mfma_f32_16x16x32_bf16 v[16:19], v[228:231], v[212:215], v[16:19]
    v_mfma_f32_16x16x32_bf16 v[20:23], v[232:235], v[204:207], v[20:23]
    v_mfma_f32_16x16x32_bf16 v[24:27], v[232:235], v[208:211], v[24:27]
    v_mfma_f32_16x16x32_bf16 v[28:31], v[232:235], v[212:215], v[28:31]
    v_mfma_f32_16x16x32_bf16 v[32:35], v[236:239], v[204:207], v[32:35]
    v_mfma_f32_16x16x32_bf16 v[36:39], v[236:239], v[208:211], v[36:39]
    v_mfma_f32_16x16x32_bf16 v[40:43], v[236:239], v[212:215], v[40:43]
    v_mfma_f32_16x16x32_bf16 v[44:47], v[240:243], v[204:207], v[44:47]
    v_mfma_f32_16x16x32_bf16 v[48:51], v[240:243], v[208:211], v[48:51]
    v_mfma_f32_16x16x32_bf16 v[52:55], v[240:243], v[212:215], v[52:55]
    buffer_load_dwordx4 v[204:207], v4, s[8:11], s28 offen sc1
    s_add_u32 s25, s28, 0x20000
    buffer_load_dwordx4 v[208:211], v4, s[8:11], s25 offen sc1
    s_add_u32 s25, s28, 0x40000
    buffer_load_dwordx4 v[212:215], v4, s[8:11], s25 offen sc1
    s_add_u32 s28, s28, 0x400
    s_and_b32 s28, s28, 0x3fff
    s_add_u32 m0, s58, 0
    s_add_u32 s25, s24, 0
    buffer_load_dwordx4 v5, s[4:7], s25 offen lds
    s_add_u32 m0, s58, 1024
    s_add_u32 s25, s24, 8192
    buffer_load_dwordx4 v5, s[4:7], s25 offen lds
    s_add_u32 m0, s58, 2048
    s_add_u32 s25, s24, 16384
    buffer_load_dwordx4 v5, s[4:7], s25 offen lds
    s_add_u32 m0, s58, 3072
    s_add_u32 s25, s24, 24576
    buffer_load_dwordx4 v5, s[4:7], s25 offen lds
    s_add_u32 s24, s24, 0x8000
    s_and_b32 s24, s24, 0x7ffff
    s_waitcnt vmcnt(54)
    ds_read_b64_tr_b16 v[228:229], v244 offset:4096
    ds_read_b64_tr_b16 v[230:231], v244 offset:6144
    ds_read_b64_tr_b16 v[232:233], v245 offset:4096
    ds_read_b64_tr_b16 v[234:235], v245 offset:6144
    ds_read_b64_tr_b16 v[236:237], v246 offset:4096
    ds_read_b64_tr_b16 v[238:239], v246 offset:6144
    ds_read_b64_tr_b16 v[240:241], v247 offset:4096
    ds_read_b64_tr_b16 v[242:243], v247 offset:6144
    s_waitcnt vmcnt(20)
    s_waitcnt lgkmcnt(0)
    v_mfma_f32_16x16x32_bf16 v[8:11], v[228:231], v[216:219], v[8:11]
    v_mfma_f32_16x16x32_bf16 v[12:15], v[228:231], v[220:223], v[12:15]
    v_mfma_f32_16x16x32_bf16 v[16:19], v[228:231], v[224:227], v[16:19]
    v_mfma_f32_16x16x32_bf16 v[20:23], v[232:235], v[216:219], v[20:23]
    v_mfma_f32_16x16x32_bf16 v[24:27], v[232:235], v[220:223], v[24:27]
    v_mfma_f32_16x16x32_bf16 v[28:31], v[232:235], v[224:227], v[28:31]
    v_mfma_f32_16x16x32_bf16 v[32:35], v[236:239], v[216:219], v[32:35]
    v_mfma_f32_16x16x32_bf16 v[36:39], v[236:239], v[220:223], v[36:39]
    v_mfma_f32_16x16x32_bf16 v[40:43], v[236:239], v[224:227], v[40:43]
    v_mfma_f32_16x16x32_bf16 v[44:47], v[240:243], v[216:219], v[44:47]
    v_mfma_f32_16x16x32_bf16 v[48:51], v[240:243], v[220:223], v[48:51]
    v_mfma_f32_16x16x32_bf16 v[52:55], v[240:243], v[224:227], v[52:55]
    buffer_load_dwordx4 v[216:219], v4, s[8:11], s28 offen sc1
    s_add_u32 s25, s28, 0x20000
    buffer_load_dwordx4 v[220:223], v4, s[8:11], s25 offen sc1
    s_add_u32 s25, s28, 0x40000
    buffer_load_dwordx4 v[224:227], v4, s[8:11], s25 offen sc1
    s_add_u32 s28, s28, 0x400
    s_and_b32 s28, s28, 0x3fff
    s_add_u32 m0, s58, 4096
    s_add_u32 s25, s24, 0
    buffer_load_dwordx4 v5, s[4:7], s25 offen lds
    s_add_u32 m0, s58, 5120
    s_add_u32 s25, s24, 8192
    buffer_load_dwordx4 v5, s[4:7], s25 offen lds
    s_add_u32 m0, s58, 6144
    s_add_u32 s25, s24, 16384
    buffer_load_dwordx4 v5, s[4:7], s25 offen lds
    s_add_u32 m0, s58, 7168
    s_add_u32 s25, s24, 24576
    buffer_load_dwordx4 v5, s[4:7], s25 offen lds
    s_add_u32 s24, s24, 0x8000
    s_and_b32 s24, s24, 0x7ffff
    s_waitcnt vmcnt(57)
    ds_read_b64_tr_b16 v[228:229], v244 offset:32768
    ds_read_b64_tr_b16 v[230:231], v244 offset:34816
    ds_read_b64_tr_b16 v[232:233], v245 offset:32768
    ds_read_b64_tr_b16 v[234:235], v245 offset:34816
    ds_read_b64_tr_b16 v[236:237], v246 offset:32768
    ds_read_b64_tr_b16 v[238:239], v246 offset:34816
    ds_read_b64_tr_b16 v[240:241], v247 offset:32768
    ds_read_b64_tr_b16 v[242:243], v247 offset:34816
    s_waitcnt vmcnt(24)
    s_waitcnt lgkmcnt(0)
    v_mfma_f32_16x16x32_bf16 v[8:11], v[228:231], v[168:171], v[8:11]
    v_mfma_f32_16x16x32_bf16 v[12:15], v[228:231], v[172:175], v[12:15]
    v_mfma_f32_16x16x32_bf16 v[16:19], v[228:231], v[176:179], v[16:19]
    v_mfma_f32_16x16x32_bf16 v[20:23], v[232:235], v[168:171], v[20:23]
    v_mfma_f32_16x16x32_bf16 v[24:27], v[232:235], v[172:175], v[24:27]
    v_mfma_f32_16x16x32_bf16 v[28:31], v[232:235], v[176:179], v[28:31]
    v_mfma_f32_16x16x32_bf16 v[32:35], v[236:239], v[168:171], v[32:35]
    v_mfma_f32_16x16x32_bf16 v[36:39], v[236:239], v[172:175], v[36:39]
    v_mfma_f32_16x16x32_bf16 v[40:43], v[236:239], v[176:179], v[40:43]
    v_mfma_f32_16x16x32_bf16 v[44:47], v[240:243], v[168:171], v[44:47]
    v_mfma_f32_16x16x32_bf16 v[48:51], v[240:243], v[172:175], v[48:51]
    v_mfma_f32_16x16x32_bf16 v[52:55], v[240:243], v[176:179], v[52:55]
    buffer_load_dwordx4 v[168:171], v4, s[8:11], s28 offen sc1
    s_add_u32 s25, s28, 0x20000
    buffer_load_dwordx4 v[172:175], v4, s[8:11], s25 offen sc1
    s_add_u32 s25, s28, 0x40000
    buffer_load_dwordx4 v[176:179], v4, s[8:11], s25 offen sc1
    s_add_u32 s28, s28, 0x400
    s_and_b32 s28, s28, 0x3fff
    s_add_u32 m0, s58, 32768
    s_add_u32 s25, s24, 0
    buffer_load_dwordx4 v5, s[4:7], s25 offen lds
    s_add_u32 m0, s58, 33792
    s_add_u32 s25, s24, 8192
    buffer_load_dwordx4 v5, s[4:7], s25 offen lds
    s_add_u32 m0, s58, 34816
    s_add_u32 s25, s24, 16384
    buffer_load_dwordx4 v5, s[4:7], s25 offen lds
    s_add_u32 m0, s58, 35840
    s_add_u32 s25, s24, 24576
    buffer_load_dwordx4 v5, s[4:7], s25 offen lds
    s_add_u32 s24, s24, 0x8000
    s_and_b32 s24, s24, 0x7ffff
    s_waitcnt vmcnt(21)
    ds_read_b64_tr_b16 v[228:229], v244 offset:36864
    ds_read_b64_tr_b16 v[230:231], v244 offset:38912
    ds_read_b64_tr_b16 v[232:233], v245 offset:36864
    ds_read_b64_tr_b16 v[234:235], v245 offset:38912
    ds_read_b64_tr_b16 v[236:237], v246 offset:36864
    ds_read_b64_tr_b16 v[238:239], v246 offset:38912
    ds_read_b64_tr_b16 v[240:241], v247 offset:36864
    ds_read_b64_tr_b16 v[242:243], v247 offset:38912
    s_waitcnt vmcnt(28)
    s_waitcnt lgkmcnt(0)
    v_mfma_f32_16x16x32_bf16 v[8:11], v[228:231], v[180:183], v[8:11]
    v_mfma_f32_16x16x32_bf16 v[12:15], v[228:231], v[184:187], v[12:15]
    v_mfma_f32_16x16x32_bf16 v[16:19], v[228:231], v[188:191], v[16:19]
    v_mfma_f32_16x16x32_bf16 v[20:23], v[232:235], v[180:183], v[20:23]
    v_mfma_f32_16x16x32_bf16 v[24:27], v[232:235], v[184:187], v[24:27]
    v_mfma_f32_16x16x32_bf16 v[28:31], v[232:235], v[188:191], v[28:31]
    v_mfma_f32_16x16x32_bf16 v[32:35], v[236:239], v[180:183], v[32:35]
    v_mfma_f32_16x16x32_bf16 v[36:39], v[236:239], v[184:187], v[36:39]
    v_mfma_f32_16x16x32_bf16 v[40:43], v[236:239], v[188:191], v[40:43]
    v_mfma_f32_16x16x32_bf16 v[44:47], v[240:243], v[180:183], v[44:47]
    v_mfma_f32_16x16x32_bf16 v[48:51], v[240:243], v[184:187], v[48:51]
    v_mfma_f32_16x16x32_bf16 v[52:55], v[240:243], v[188:191], v[52:55]
    s_add_u32 m0, s58, 36864
    s_add_u32 s25, s24, 0
    buffer_load_dwordx4 v5, s[4:7], s25 offen lds
    s_add_u32 m0, s58, 37888
    s_add_u32 s25, s24, 8192
    buffer_load_dwordx4 v5, s[4:7], s25 offen lds
    s_add_u32 m0, s58, 38912
    s_add_u32 s25, s24, 16384
    buffer_load_dwordx4 v5, s[4:7], s25 offen lds
    s_add_u32 m0, s58, 39936
    s_add_u32 s25, s24, 24576
    buffer_load_dwordx4 v5, s[4:7], s25 offen lds
    s_add_u32 s24, s24, 0x8000
    s_and_b32 s24, s24, 0x7ffff
    s_waitcnt vmcnt(18)
    ds_read_b64_tr_b16 v[228:229], v244 offset:0
    ds_read_b64_tr_b16 v[230:231], v244 offset:2048
    ds_read_b64_tr_b16 v[232:233], v245 offset:0
    ds_read_b64_tr_b16 v[234:235], v245 offset:2048
    ds_read_b64_tr_b16 v[236:237], v246 offset:0
    ds_read_b64_tr_b16 v[238:239], v246 offset:2048
    ds_read_b64_tr_b16 v[240:241], v247 offset:0
    ds_read_b64_tr_b16 v[242:243], v247 offset:2048
    s_waitcnt vmcnt(29)
    s_waitcnt lgkmcnt(0)
    v_mfma_f32_16x16x32_bf16 v[8:11], v[228:231], v[192:195], v[8:11]
    v_mfma_f32_16x16x32_bf16 v[12:15], v[228:231], v[196:199], v[12:15]
    v_mfma_f32_16x16x32_bf16 v[16:19], v[228:231], v[200:203], v[16:19]
    v_mfma_f32_16x16x32_bf16 v[20:23], v[232:235], v[192:195], v[20:23]
    v_mfma_f32_16x16x32_bf16 v[24:27], v[232:235], v[196:199], v[24:27]
    v_mfma_f32_16x16x32_bf16 v[28:31], v[232:235], v[200:203], v[28:31]
    v_mfma_f32_16x16x32_bf16 v[32:35], v[236:239], v[192:195], v[32:35]
    v_mfma_f32_16x16x32_bf16 v[36:39], v[236:239], v[196:199], v[36:39]
    v_mfma_f32_16x16x32_bf16 v[40:43], v[236:239], v[200:203], v[40:43]
    v_mfma_f32_16x16x32_bf16 v[44:47], v[240:243], v[192:195], v[44:47]
    v_mfma_f32_16x16x32_bf16 v[48:51], v[240:243], v[196:199], v[48:51]
    v_mfma_f32_16x16x32_bf16 v[52:55], v[240:243], v[200:203], v[52:55]
    s_waitcnt vmcnt(11)
    ds_read_b64_tr_b16 v[228:229], v244 offset:4096
    ds_read_b64_tr_b16 v[230:231], v244 offset:6144
    ds_read_b64_tr_b16 v[232:233], v245 offset:4096
    ds_read_b64_tr_b16 v[234:235], v245 offset:6144
    ds_read_b64_tr_b16 v[236:237], v246 offset:4096
    ds_read_b64_tr_b16 v[238:239], v246 offset:6144
    ds_read_b64_tr_b16 v[240:241], v247 offset:4096
    ds_read_b64_tr_b16 v[242:243], v247 offset:6144
    s_waitcnt vmcnt(22)
    s_waitcnt lgkmcnt(0)
    v_mfma_f32_16x16x32_bf16 v[8:11], v[228:231], v[204:207], v[8:11]
    v_mfma_f32_16x16x32_bf16 v[12:15], v[228:231], v[208:211], v[12:15]
    v_mfma_f32_16x16x32_bf16 v[16:19], v[228:231], v[212:215], v[16:19]
    v_mfma_f32_16x16x32_bf16 v[20:23], v[232:235], v[204:207], v[20:23]
    v_mfma_f32_16x16x32_bf16 v[24:27], v[232:235], v[208:211], v[24:27]
    v_mfma_f32_16x16x32_bf16 v[28:31], v[232:235], v[212:215], v[28:31]
    v_mfma_f32_16x16x32_bf16 v[32:35], v[236:239], v[204:207], v[32:35]
    v_mfma_f32_16x16x32_bf16 v[36:39], v[236:239], v[208:211], v[36:39]
    v_mfma_f32_16x16x32_bf16 v[40:43], v[236:239], v[212:215], v[40:43]
    v_mfma_f32_16x16x32_bf16 v[44:47], v[240:243], v[204:207], v[44:47]
    v_mfma_f32_16x16x32_bf16 v[48:51], v[240:243], v[208:211], v[48:51]
    v_mfma_f32_16x16x32_bf16 v[52:55], v[240:243], v[212:215], v[52:55]
    s_waitcnt vmcnt(4)
    ds_read_b64_tr_b16 v[228:229], v244 offset:32768
    ds_read_b64_tr_b16 v[230:231], v244 offset:34816
    ds_read_b64_tr_b16 v[232:233], v245 offset:32768
    ds_read_b64_tr_b16 v[234:235], v245 offset:34816
    ds_read_b64_tr_b16 v[236:237], v246 offset:32768
    ds_read_b64_tr_b16 v[238:239], v246 offset:34816
    ds_read_b64_tr_b16 v[240:241], v247 offset:32768
    ds_read_b64_tr_b16 v[242:243], v247 offset:34816
    s_waitcnt vmcnt(15)
    s_waitcnt lgkmcnt(0)
    v_mfma_f32_16x16x32_bf16 v[8:11], v[228:231], v[216:219], v[8:11]
    v_mfma_f32_16x16x32_bf16 v[12:15], v[228:231], v[220:223], v[12:15]
    v_mfma_f32_16x16x32_bf16 v[16:19], v[228:231], v[224:227], v[16:19]
    v_mfma_f32_16x16x32_bf16 v[20:23], v[232:235], v[216:219], v[20:23]
    v_mfma_f32_16x16x32_bf16 v[24:27], v[232:235], v[220:223], v[24:27]
    v_mfma_f32_16x16x32_bf16 v[28:31], v[232:235], v[224:227], v[28:31]
    v_mfma_f32_16x16x32_bf16 v[32:35], v[236:239], v[216:219], v[32:35]
    v_mfma_f32_16x16x32_bf16 v[36:39], v[236:239], v[220:223], v[36:39]
    v_mfma_f32_16x16x32_bf16 v[40:43], v[236:239], v[224:227], v[40:43]
    v_mfma_f32_16x16x32_bf16 v[44:47], v[240:243], v[216:219], v[44:47]
    v_mfma_f32_16x16x32_bf16 v[48:51], v[240:243], v[220:223], v[48:51]
    v_mfma_f32_16x16x32_bf16 v[52:55], v[240:243], v[224:227], v[52:55]
    s_waitcnt vmcnt(0)
    ds_read_b64_tr_b16 v[228:229], v244 offset:36864
    ds_read_b64_tr_b16 v[230:231], v244 offset:38912
    ds_read_b64_tr_b16 v[232:233], v245 offset:36864
    ds_read_b64_tr_b16 v[234:235], v245 offset:38912
    ds_read_b64_tr_b16 v[236:237], v246 offset:36864
    ds_read_b64_tr_b16 v[238:239], v246 offset:38912
    ds_read_b64_tr_b16 v[240:241], v247 offset:36864
    ds_read_b64_tr_b16 v[242:243], v247 offset:38912
    s_waitcnt vmcnt(8)
    s_waitcnt lgkmcnt(0)
    v_mfma_f32_16x16x32_bf16 v[8:11], v[228:231], v[168:171], v[8:11]
    v_mfma_f32_16x16x32_bf16 v[12:15], v[228:231], v[172:175], v[12:15]
    v_mfma_f32_16x16x32_bf16 v[16:19], v[228:231], v[176:179], v[16:19]
    v_mfma_f32_16x16x32_bf16 v[20:23], v[232:235], v[168:171], v[20:23]
    v_mfma_f32_16x16x32_bf16 v[24:27], v[232:235], v[172:175], v[24:27]
    v_mfma_f32_16x16x32_bf16 v[28:31], v[232:235], v[176:179], v[28:31]
    v_mfma_f32_16x16x32_bf16 v[32:35], v[236:239], v[168:171], v[32:35]
    v_mfma_f32_16x16x32_bf16 v[36:39], v[236:239], v[172:175], v[36:39]
    v_mfma_f32_16x16x32_bf16 v[40:43], v[236:239], v[176:179], v[40:43]
    v_mfma_f32_16x16x32_bf16 v[44:47], v[240:243], v[168:171], v[44:47]
    v_mfma_f32_16x16x32_bf16 v[48:51], v[240:243], v[172:175], v[48:51]
    v_mfma_f32_16x16x32_bf16 v[52:55], v[240:243], v[176:179], v[52:55]
    s_barrier
    s_mul_i32 s54, s20, 12288
    v_add_u32 v1, s54, v4
    s_nop 7
    ds_write_b128 v1, v[8:11] offset:0
    ds_write_b128 v1, v[12:15] offset:1024
    ds_write_b128 v1, v[16:19] offset:2048
    ds_write_b128 v1, v[20:23] offset:3072
    ds_write_b128 v1, v[24:27] offset:4096
    ds_write_b128 v1, v[28:31] offset:5120
    ds_write_b128 v1, v[32:35] offset:6144
    ds_write_b128 v1, v[36:39] offset:7168
    ds_write_b128 v1, v[40:43] offset:8192
    ds_write_b128 v1, v[44:47] offset:9216
    ds_write_b128 v1, v[48:51] offset:10240
    ds_write_b128 v1, v[52:55] offset:11264
    s_waitcnt lgkmcnt(0)
    s_barrier
    s_mul_i32 s54, s20, 3072
    v_add_u32 v1, s54, v4
    ds_read_b128 v[56:59], v1 offset:0
    ds_read_b128 v[60:63], v1 offset:1024
    ds_read_b128 v[64:67], v1 offset:2048
    ds_read_b128 v[68:71], v1 offset:12288
    ds_read_b128 v[72:75], v1 offset:13312
    ds_read_b128 v[76:79], v1 offset:14336
    ds_read_b128 v[80:83], v1 offset:24576
    ds_read_b128 v[84:87], v1 offset:25600
    ds_read_b128 v[88:91], v1 offset:26624
    ds_read_b128 v[92:95], v1 offset:36864
    ds_read_b128 v[96:99], v1 offset:37888
    ds_read_b128 v[100:103], v1 offset:38912
    s_lshl_b32 s54, s36, 3
    s_add_u32 s54, s54, s37
    s_lshl_b32 s54, s54, 3
    s_add_u32 s54, s54, s38
    s_mul_i32 s54, s54, 12288
    s_mul_i32 s55, s20, 3072
    s_add_u32 s54, s54, s55
    s_add_u32 s54, s54, 50331648
    s_add_u32 s16, s70, s54
    s_addc_u32 s17, s71, 0
    s_mov_b32 s18, 3072
    s_mov_b32 s19, 0x20000
    s_waitcnt lgkmcnt(0)
    v_add_f32 v56, v56, v68
    v_add_f32 v80, v80, v92
    v_add_f32 v57, v57, v69
    v_add_f32 v81, v81, v93
    v_add_f32 v58, v58, v70
    v_add_f32 v82, v82, v94
    v_add_f32 v59, v59, v71
    v_add_f32 v83, v83, v95
    v_add_f32 v60, v60, v72
    v_add_f32 v84, v84, v96
    v_add_f32 v61, v61, v73
    v_add_f32 v85, v85, v97
    v_add_f32 v62, v62, v74
    v_add_f32 v86, v86, v98
    v_add_f32 v63, v63, v75
    v_add_f32 v87, v87, v99
    v_add_f32 v64, v64, v76
    v_add_f32 v88, v88, v100
    v_add_f32 v65, v65, v77
    v_add_f32 v89, v89, v101
    v_add_f32 v66, v66, v78
    v_add_f32 v90, v90, v102
    v_add_f32 v67, v67, v79
    v_add_f32 v91, v91, v103
    v_add_f32 v56, v56, v80
    v_add_f32 v57, v57, v81
    v_add_f32 v58, v58, v82
    v_add_f32 v59, v59, v83
    v_add_f32 v60, v60, v84
    v_add_f32 v61, v61, v85
    v_add_f32 v62, v62, v86
    v_add_f32 v63, v63, v87
    v_add_f32 v64, v64, v88
    v_add_f32 v65, v65, v89
    v_add_f32 v66, v66, v90
    v_add_f32 v67, v67, v91
    s_lshr_b32 s55, s20, 1
    s_cmp_eq_u32 s55, s39
    s_cbranch_scc1 PX_KEEP
    buffer_store_dwordx4 v[56:59], v4, s[16:19], 0 offen offset:0 sc1
    buffer_store_dwordx4 v[60:63], v4, s[16:19], 0 offen offset:1024 sc1
    buffer_store_dwordx4 v[64:67], v4, s[16:19], 0 offen offset:2048 sc1
    s_waitcnt vmcnt(0)
PX_KEEP:
    s_barrier
    s_cmp_lg_u32 s20, 0
    s_cbranch_scc1 PX_D
    s_memrealtime s[54:55]
    s_lshl_b32 s56, s36, 3
    s_add_u32 s56, s56, s37
    s_lshl_b32 s56, s56, 3
    s_add_u32 s56, s56, s38
    s_lshl_b32 s56, s56, 7
    s_add_u32 s57, s56, 32768
    s_add_u32 s57, s57, 41943040
    s_add_u32 s40, s70, s57
    s_addc_u32 s41, s71, 0
    s_mov_b32 s42, 8
    s_mov_b32 s43, 0x20000
    s_lshl_b32 s57, s39, 2
    v_mov_b32 v248, s57
    s_waitcnt lgkmcnt(0)
    s_or_b32 s54, s54, 1
    v_mov_b32 v249, s54
    s_mov_b64 exec, 1
    buffer_store_dword v249, v248, s[40:43], 0 offen sc1
    s_mov_b64 exec, -1
    s_xor_b32 s57, s39, 1
    v_readlane_b32 s55, v7, s57
    s_lshl_b32 s57, s57, 2
    v_mov_b32 v248, s57
    s_nop 1
    v_mov_b32 v251, s55
    s_mov_b32 s56, 0x3ffff
    s_mov_b32 exec_lo, 1
    s_mov_b32 exec_hi, 0
PX_L:
    buffer_load_dword v249, v248, s[40:43], 0 offen sc1
    s_waitcnt vmcnt(0)
    v_cmp_eq_u32 vcc, v249, v251
    s_cbranch_vccz PX_E
    s_sleep 4
    s_sub_u32 s56, s56, 1
    s_cmp_lg_u32 s56, 0
    s_cbranch_scc1 PX_L
PX_E:
    s_mov_b64 exec, -1
PX_D:
    s_barrier
    s_lshr_b32 s55, s20, 1
    s_cmp_lg_u32 s55, s39
    s_cbranch_scc1 FIN
    buffer_load_dwordx4 v[68:71], v4, s[16:19], 0 offen offset:0 sc1
    buffer_load_dwordx4 v[72:75], v4, s[16:19], 0 offen offset:1024 sc1
    buffer_load_dwordx4 v[76:79], v4, s[16:19], 0 offen offset:2048 sc1
    v_and_b32 v2, 15, v0
    v_lshrrev_b32 v1, 4, v0
    v_lshlrev_b32 v2, 11, v2
    v_lshl_add_u32 v2, v1, 3, v2
    s_mov_b32 s12, s66
    s_mov_b32 s13, s67
    s_mov_b32 s14, 786432
    s_mov_b32 s15, 0x20000
    s_mul_i32 s54, s37, 48
    s_lshl_b32 s54, s54, 11
    s_lshl_b32 s55, s36, 10
    s_add_u32 s54, s54, s55
    s_lshl_b32 s55, s38, 7
    s_add_u32 s54, s54, s55
    s_lshl_b32 s55, s20, 5
    s_add_u32 s54, s54, s55
    s_waitcnt vmcnt(0)
    v_add_f32 v56, v56, v68
    v_add_f32 v57, v57, v69
    v_add_f32 v58, v58, v70
    v_add_f32 v59, v59, v71
    v_cvt_pk_bf16_f32 v80, v56, v57
    v_cvt_pk_bf16_f32 v81, v58, v59
    s_add_u32 s55, s54, 0
    buffer_store_dwordx2 v[80:81], v2, s[12:15], s55 offen
    v_add_f32 v60, v60, v72
    v_add_f32 v61, v61, v73
    v_add_f32 v62, v62, v74
    v_add_f32 v63, v63, v75
    v_cvt_pk_bf16_f32 v82, v60, v61
    v_cvt_pk_bf16_f32 v83, v62, v63
    s_add_u32 s55, s54, 32768
    buffer_store_dwordx2 v[82:83], v2, s[12:15], s55 offen
    v_add_f32 v64, v64, v76
    v_add_f32 v65, v65, v77
    v_add_f32 v66, v66, v78
    v_add_f32 v67, v67, v79
    v_cvt_pk_bf16_f32 v84, v64, v65
    v_cvt_pk_bf16_f32 v85, v66, v67
    s_add_u32 s55, s54, 65536
    buffer_store_dwordx2 v[84:85], v2, s[12:15], s55 offen
    s_branch FIN
SLOW_AL:
    v_max3_f32 v32, v184, v185, v186
    v_max3_f32 v32, v32, v187, v196
    v_max3_f32 v32, v32, v197, v198
    v_max_f32 v32, v32, v199
    v_max3_f32 v33, v188, v189, v190
    v_max3_f32 v33, v33, v191, v200
    v_max3_f32 v33, v33, v201, v202
    v_max_f32 v33, v33, v203
    v_max3_f32 v34, v192, v193, v194
    v_max3_f32 v34, v34, v195, v204
    v_max3_f32 v34, v34, v205, v206
    v_max_f32 v34, v34, v207
    v_mov_b32 v31, v32
    s_nop 1
    v_permlane32_swap_b32 v32, v31
    s_nop 1
    v_max_f32 v32, v32, v31
    v_mov_b32 v31, v32
    s_nop 1
    v_permlane16_swap_b32 v32, v31
    s_nop 1
    v_max_f32 v32, v32, v31
    v_mov_b32 v31, v33
    s_nop 1
    v_permlane32_swap_b32 v33, v31
    s_nop 1
    v_max_f32 v33, v33, v31
    v_mov_b32 v31, v33
    s_nop 1
    v_permlane16_swap_b32 v33, v31
    s_nop 1
    v_max_f32 v33, v33, v31
    v_mov_b32 v31, v34
    s_nop 1
    v_permlane32_swap_b32 v34, v31
    s_nop 1
    v_max_f32 v34, v34, v31
    v_mov_b32 v31, v34
    s_nop 1
    v_permlane16_swap_b32 v34, v31
    s_nop 1
    v_max_f32 v34, v34, v31
    v_mul_f32 v32, s30, v32
    v_max_f32 v32, v32, v22
    v_sub_f32 v36, v22, v32
    v_exp_f32 v36, v36
    v_mov_b32 v22, v32
    v_mul_f32 v25, v25, v36
    v_mul_f32 v88, v88, v36
    v_mul_f32 v89, v89, v36
    v_mul_f32 v90, v90, v36
    v_mul_f32 v91, v91, v36
    v_mul_f32 v100, v100, v36
    v_mul_f32 v101, v101, v36
    v_mul_f32 v102, v102, v36
    v_mul_f32 v103, v103, v36
    v_mul_f32 v112, v112, v36
    v_mul_f32 v113, v113, v36
    v_mul_f32 v114, v114, v36
    v_mul_f32 v115, v115, v36
    v_mul_f32 v124, v124, v36
    v_mul_f32 v125, v125, v36
    v_mul_f32 v126, v126, v36
    v_mul_f32 v127, v127, v36
    v_mul_f32 v136, v136, v36
    v_mul_f32 v137, v137, v36
    v_mul_f32 v138, v138, v36
    v_mul_f32 v139, v139, v36
    v_mul_f32 v148, v148, v36
    v_mul_f32 v149, v149, v36
    v_mul_f32 v150, v150, v36
    v_mul_f32 v151, v151, v36
    v_mul_f32 v160, v160, v36
    v_mul_f32 v161, v161, v36
    v_mul_f32 v162, v162, v36
    v_mul_f32 v163, v163, v36
    v_mul_f32 v172, v172, v36
    v_mul_f32 v173, v173, v36
    v_mul_f32 v174, v174, v36
    v_mul_f32 v175, v175, v36
    v_mul_f32 v33, s30, v33
    v_max_f32 v33, v33, v23
    v_sub_f32 v37, v23, v33
    v_exp_f32 v37, v37
    v_mov_b32 v23, v33
    v_mul_f32 v26, v26, v37
    v_mul_f32 v92, v92, v37
    v_mul_f32 v93, v93, v37
    v_mul_f32 v94, v94, v37
    v_mul_f32 v95, v95, v37
    v_mul_f32 v104, v104, v37
    v_mul_f32 v105, v105, v37
    v_mul_f32 v106, v106, v37
    v_mul_f32 v107, v107, v37
    v_mul_f32 v116, v116, v37
    v_mul_f32 v117, v117, v37
    v_mul_f32 v118, v118, v37
    v_mul_f32 v119, v119, v37
    v_mul_f32 v128, v128, v37
    v_mul_f32 v129, v129, v37
    v_mul_f32 v130, v130, v37
    v_mul_f32 v131, v131, v37
    v_mul_f32 v140, v140, v37
    v_mul_f32 v141, v141, v37
    v_mul_f32 v142, v142, v37
    v_mul_f32 v143, v143, v37
    v_mul_f32 v152, v152, v37
    v_mul_f32 v153, v153, v37
    v_mul_f32 v154, v154, v37
    v_mul_f32 v155, v155, v37
    v_mul_f32 v164, v164, v37
    v_mul_f32 v165, v165, v37
    v_mul_f32 v166, v166, v37
    v_mul_f32 v167, v167, v37
    v_mul_f32 v176, v176, v37
    v_mul_f32 v177, v177, v37
    v_mul_f32 v178, v178, v37
    v_mul_f32 v179, v179, v37
    v_mul_f32 v34, s30, v34
    v_max_f32 v34, v34, v24
    v_sub_f32 v38, v24, v34
    v_exp_f32 v38, v38
    v_mov_b32 v24, v34
    v_mul_f32 v27, v27, v38
    v_mul_f32 v96, v96, v38
    v_mul_f32 v97, v97, v38
    v_mul_f32 v98, v98, v38
    v_mul_f32 v99, v99, v38
    v_mul_f32 v108, v108, v38
    v_mul_f32 v109, v109, v38
    v_mul_f32 v110, v110, v38
    v_mul_f32 v111, v111, v38
    v_mul_f32 v120, v120, v38
    v_mul_f32 v121, v121, v38
    v_mul_f32 v122, v122, v38
    v_mul_f32 v123, v123, v38
    v_mul_f32 v132, v132, v38
    v_mul_f32 v133, v133, v38
    v_mul_f32 v134, v134, v38
    v_mul_f32 v135, v135, v38
    v_mul_f32 v144, v144, v38
    v_mul_f32 v145, v145, v38
    v_mul_f32 v146, v146, v38
    v_mul_f32 v147, v147, v38
    v_mul_f32 v156, v156, v38
    v_mul_f32 v157, v157, v38
    v_mul_f32 v158, v158, v38
    v_mul_f32 v159, v159, v38
    v_mul_f32 v168, v168, v38
    v_mul_f32 v169, v169, v38
    v_mul_f32 v170, v170, v38
    v_mul_f32 v171, v171, v38
    v_mul_f32 v180, v180, v38
    v_mul_f32 v181, v181, v38
    v_mul_f32 v182, v182, v38
    v_mul_f32 v183, v183, v38
    s_mov_b32 s31, 0x7f800000
    s_branch SM_AL
SLOW_AU:
    v_max3_f32 v32, v184, v185, v186
    v_max3_f32 v32, v32, v187, v196
    v_max3_f32 v32, v32, v197, v198
    v_max_f32 v32, v32, v199
    v_max3_f32 v33, v188, v189, v190
    v_max3_f32 v33, v33, v191, v200
    v_max3_f32 v33, v33, v201, v202
    v_max_f32 v33, v33, v203
    v_max3_f32 v34, v192, v193, v194
    v_max3_f32 v34, v34, v195, v204
    v_max3_f32 v34, v34, v205, v206
    v_max_f32 v34, v34, v207
    v_mov_b32 v31, v32
    s_nop 1
    v_permlane32_swap_b32 v32, v31
    s_nop 1
    v_max_f32 v32, v32, v31
    v_mov_b32 v31, v32
    s_nop 1
    v_permlane16_swap_b32 v32, v31
    s_nop 1
    v_max_f32 v32, v32, v31
    v_mov_b32 v31, v33
    s_nop 1
    v_permlane32_swap_b32 v33, v31
    s_nop 1
    v_max_f32 v33, v33, v31
    v_mov_b32 v31, v33
    s_nop 1
    v_permlane16_swap_b32 v33, v31
    s_nop 1
    v_max_f32 v33, v33, v31
    v_mov_b32 v31, v34
    s_nop 1
    v_permlane32_swap_b32 v34, v31
    s_nop 1
    v_max_f32 v34, v34, v31
    v_mov_b32 v31, v34
    s_nop 1
    v_permlane16_swap_b32 v34, v31
    s_nop 1
    v_max_f32 v34, v34, v31
    v_mul_f32 v32, s30, v32
    v_max_f32 v32, v32, v22
    v_sub_f32 v36, v22, v32
    v_exp_f32 v36, v36
    v_mov_b32 v22, v32
    v_mul_f32 v25, v25, v36
    v_mul_f32 v88, v88, v36
    v_mul_f32 v89, v89, v36
    v_mul_f32 v90, v90, v36
    v_mul_f32 v91, v91, v36
    v_mul_f32 v100, v100, v36
    v_mul_f32 v101, v101, v36
    v_mul_f32 v102, v102, v36
    v_mul_f32 v103, v103, v36
    v_mul_f32 v112, v112, v36
    v_mul_f32 v113, v113, v36
    v_mul_f32 v114, v114, v36
    v_mul_f32 v115, v115, v36
    v_mul_f32 v124, v124, v36
    v_mul_f32 v125, v125, v36
    v_mul_f32 v126, v126, v36
    v_mul_f32 v127, v127, v36
    v_mul_f32 v136, v136, v36
    v_mul_f32 v137, v137, v36
    v_mul_f32 v138, v138, v36
    v_mul_f32 v139, v139, v36
    v_mul_f32 v148, v148, v36
    v_mul_f32 v149, v149, v36
    v_mul_f32 v150, v150, v36
    v_mul_f32 v151, v151, v36
    v_mul_f32 v160, v160, v36
    v_mul_f32 v161, v161, v36
    v_mul_f32 v162, v162, v36
    v_mul_f32 v163, v163, v36
    v_mul_f32 v172, v172, v36
    v_mul_f32 v173, v173, v36
    v_mul_f32 v174, v174, v36
    v_mul_f32 v175, v175, v36
    v_mul_f32 v33, s30, v33
    v_max_f32 v33, v33, v23
    v_sub_f32 v37, v23, v33
    v_exp_f32 v37, v37
    v_mov_b32 v23, v33
    v_mul_f32 v26, v26, v37
    v_mul_f32 v92, v92, v37
    v_mul_f32 v93, v93, v37
    v_mul_f32 v94, v94, v37
    v_mul_f32 v95, v95, v37
    v_mul_f32 v104, v104, v37
    v_mul_f32 v105, v105, v37
    v_mul_f32 v106, v106, v37
    v_mul_f32 v107, v107, v37
    v_mul_f32 v116, v116, v37
    v_mul_f32 v117, v117, v37
    v_mul_f32 v118, v118, v37
    v_mul_f32 v119, v119, v37
    v_mul_f32 v128, v128, v37
    v_mul_f32 v129, v129, v37
    v_mul_f32 v130, v130, v37
    v_mul_f32 v131, v131, v37
    v_mul_f32 v140, v140, v37
    v_mul_f32 v141, v141, v37
    v_mul_f32 v142, v142, v37
    v_mul_f32 v143, v143, v37
    v_mul_f32 v152, v152, v37
    v_mul_f32 v153, v153, v37
    v_mul_f32 v154, v154, v37
    v_mul_f32 v155, v155, v37
    v_mul_f32 v164, v164, v37
    v_mul_f32 v165, v165, v37
    v_mul_f32 v166, v166, v37
    v_mul_f32 v167, v167, v37
    v_mul_f32 v176, v176, v37
    v_mul_f32 v177, v177, v37
    v_mul_f32 v178, v178, v37
    v_mul_f32 v179, v179, v37
    v_mul_f32 v34, s30, v34
    v_max_f32 v34, v34, v24
    v_sub_f32 v38, v24, v34
    v_exp_f32 v38, v38
    v_mov_b32 v24, v34
    v_mul_f32 v27, v27, v38
    v_mul_f32 v96, v96, v38
    v_mul_f32 v97, v97, v38
    v_mul_f32 v98, v98, v38
    v_mul_f32 v99, v99, v38
    v_mul_f32 v108, v108, v38
    v_mul_f32 v109, v109, v38
    v_mul_f32 v110, v110, v38
    v_mul_f32 v111, v111, v38
    v_mul_f32 v120, v120, v38
    v_mul_f32 v121, v121, v38
    v_mul_f32 v122, v122, v38
    v_mul_f32 v123, v123, v38
    v_mul_f32 v132, v132, v38
    v_mul_f32 v133, v133, v38
    v_mul_f32 v134, v134, v38
    v_mul_f32 v135, v135, v38
    v_mul_f32 v144, v144, v38
    v_mul_f32 v145, v145, v38
    v_mul_f32 v146, v146, v38
    v_mul_f32 v147, v147, v38
    v_mul_f32 v156, v156, v38
    v_mul_f32 v157, v157, v38
    v_mul_f32 v158, v158, v38
    v_mul_f32 v159, v159, v38
    v_mul_f32 v168, v168, v38
    v_mul_f32 v169, v169, v38
    v_mul_f32 v170, v170, v38
    v_mul_f32 v171, v171, v38
    v_mul_f32 v180, v180, v38
    v_mul_f32 v181, v181, v38
    v_mul_f32 v182, v182, v38
    v_mul_f32 v183, v183, v38
    s_mov_b32 s31, 0x7f800000
    s_branch SM_AU
SLOW_A2:
    v_max3_f32 v32, v184, v185, v186
    v_max3_f32 v32, v32, v187, v196
    v_max3_f32 v32, v32, v197, v198
    v_max_f32 v32, v32, v199
    v_max3_f32 v33, v188, v189, v190
    v_max3_f32 v33, v33, v191, v200
    v_max3_f32 v33, v33, v201, v202
    v_max_f32 v33, v33, v203
    v_max3_f32 v34, v192, v193, v194
    v_max3_f32 v34, v34, v195, v204
    v_max3_f32 v34, v34, v205, v206
    v_max_f32 v34, v34, v207
    v_mov_b32 v31, v32
    s_nop 1
    v_permlane32_swap_b32 v32, v31
    s_nop 1
    v_max_f32 v32, v32, v31
    v_mov_b32 v31, v32
    s_nop 1
    v_permlane16_swap_b32 v32, v31
    s_nop 1
    v_max_f32 v32, v32, v31
    v_mov_b32 v31, v33
    s_nop 1
    v_permlane32_swap_b32 v33, v31
    s_nop 1
    v_max_f32 v33, v33, v31
    v_mov_b32 v31, v33
    s_nop 1
    v_permlane16_swap_b32 v33, v31
    s_nop 1
    v_max_f32 v33, v33, v31
    v_mov_b32 v31, v34
    s_nop 1
    v_permlane32_swap_b32 v34, v31
    s_nop 1
    v_max_f32 v34, v34, v31
    v_mov_b32 v31, v34
    s_nop 1
    v_permlane16_swap_b32 v34, v31
    s_nop 1
    v_max_f32 v34, v34, v31
    v_mul_f32 v32, s30, v32
    v_max_f32 v32, v32, v22
    v_sub_f32 v36, v22, v32
    v_exp_f32 v36, v36
    v_mov_b32 v22, v32
    v_mul_f32 v25, v25, v36
    v_mul_f32 v88, v88, v36
    v_mul_f32 v89, v89, v36
    v_mul_f32 v90, v90, v36
    v_mul_f32 v91, v91, v36
    v_mul_f32 v100, v100, v36
    v_mul_f32 v101, v101, v36
    v_mul_f32 v102, v102, v36
    v_mul_f32 v103, v103, v36
    v_mul_f32 v112, v112, v36
    v_mul_f32 v113, v113, v36
    v_mul_f32 v114, v114, v36
    v_mul_f32 v115, v115, v36
    v_mul_f32 v124, v124, v36
    v_mul_f32 v125, v125, v36
    v_mul_f32 v126, v126, v36
    v_mul_f32 v127, v127, v36
    v_mul_f32 v136, v136, v36
    v_mul_f32 v137, v137, v36
    v_mul_f32 v138, v138, v36
    v_mul_f32 v139, v139, v36
    v_mul_f32 v148, v148, v36
    v_mul_f32 v149, v149, v36
    v_mul_f32 v150, v150, v36
    v_mul_f32 v151, v151, v36
    v_mul_f32 v160, v160, v36
    v_mul_f32 v161, v161, v36
    v_mul_f32 v162, v162, v36
    v_mul_f32 v163, v163, v36
    v_mul_f32 v172, v172, v36
    v_mul_f32 v173, v173, v36
    v_mul_f32 v174, v174, v36
    v_mul_f32 v175, v175, v36
    v_mul_f32 v33, s30, v33
    v_max_f32 v33, v33, v23
    v_sub_f32 v37, v23, v33
    v_exp_f32 v37, v37
    v_mov_b32 v23, v33
    v_mul_f32 v26, v26, v37
    v_mul_f32 v92, v92, v37
    v_mul_f32 v93, v93, v37
    v_mul_f32 v94, v94, v37
    v_mul_f32 v95, v95, v37
    v_mul_f32 v104, v104, v37
    v_mul_f32 v105, v105, v37
    v_mul_f32 v106, v106, v37
    v_mul_f32 v107, v107, v37
    v_mul_f32 v116, v116, v37
    v_mul_f32 v117, v117, v37
    v_mul_f32 v118, v118, v37
    v_mul_f32 v119, v119, v37
    v_mul_f32 v128, v128, v37
    v_mul_f32 v129, v129, v37
    v_mul_f32 v130, v130, v37
    v_mul_f32 v131, v131, v37
    v_mul_f32 v140, v140, v37
    v_mul_f32 v141, v141, v37
    v_mul_f32 v142, v142, v37
    v_mul_f32 v143, v143, v37
    v_mul_f32 v152, v152, v37
    v_mul_f32 v153, v153, v37
    v_mul_f32 v154, v154, v37
    v_mul_f32 v155, v155, v37
    v_mul_f32 v164, v164, v37
    v_mul_f32 v165, v165, v37
    v_mul_f32 v166, v166, v37
    v_mul_f32 v167, v167, v37
    v_mul_f32 v176, v176, v37
    v_mul_f32 v177, v177, v37
    v_mul_f32 v178, v178, v37
    v_mul_f32 v179, v179, v37
    v_mul_f32 v34, s30, v34
    v_max_f32 v34, v34, v24
    v_sub_f32 v38, v24, v34
    v_exp_f32 v38, v38
    v_mov_b32 v24, v34
    v_mul_f32 v27, v27, v38
    v_mul_f32 v96, v96, v38
    v_mul_f32 v97, v97, v38
    v_mul_f32 v98, v98, v38
    v_mul_f32 v99, v99, v38
    v_mul_f32 v108, v108, v38
    v_mul_f32 v109, v109, v38
    v_mul_f32 v110, v110, v38
    v_mul_f32 v111, v111, v38
    v_mul_f32 v120, v120, v38
    v_mul_f32 v121, v121, v38
    v_mul_f32 v122, v122, v38
    v_mul_f32 v123, v123, v38
    v_mul_f32 v132, v132, v38
    v_mul_f32 v133, v133, v38
    v_mul_f32 v134, v134, v38
    v_mul_f32 v135, v135, v38
    v_mul_f32 v144, v144, v38
    v_mul_f32 v145, v145, v38
    v_mul_f32 v146, v146, v38
    v_mul_f32 v147, v147, v38
    v_mul_f32 v156, v156, v38
    v_mul_f32 v157, v157, v38
    v_mul_f32 v158, v158, v38
    v_mul_f32 v159, v159, v38
    v_mul_f32 v168, v168, v38
    v_mul_f32 v169, v169, v38
    v_mul_f32 v170, v170, v38
    v_mul_f32 v171, v171, v38
    v_mul_f32 v180, v180, v38
    v_mul_f32 v181, v181, v38
    v_mul_f32 v182, v182, v38
    v_mul_f32 v183, v183, v38
    s_mov_b32 s31, 0x7f800000
    s_branch SM_A2
SLOW_AF:
    v_max3_f32 v32, v184, v185, v186
    v_max3_f32 v32, v32, v187, v196
    v_max3_f32 v32, v32, v197, v198
    v_max_f32 v32, v32, v199
    v_max3_f32 v33, v188, v189, v190
    v_max3_f32 v33, v33, v191, v200
    v_max3_f32 v33, v33, v201, v202
    v_max_f32 v33, v33, v203
    v_max3_f32 v34, v192, v193, v194
    v_max3_f32 v34, v34, v195, v204
    v_max3_f32 v34, v34, v205, v206
    v_max_f32 v34, v34, v207
    v_mov_b32 v31, v32
    s_nop 1
    v_permlane32_swap_b32 v32, v31
    s_nop 1
    v_max_f32 v32, v32, v31
    v_mov_b32 v31, v32
    s_nop 1
    v_permlane16_swap_b32 v32, v31
    s_nop 1
    v_max_f32 v32, v32, v31
    v_mov_b32 v31, v33
    s_nop 1
    v_permlane32_swap_b32 v33, v31
    s_nop 1
    v_max_f32 v33, v33, v31
    v_mov_b32 v31, v33
    s_nop 1
    v_permlane16_swap_b32 v33, v31
    s_nop 1
    v_max_f32 v33, v33, v31
    v_mov_b32 v31, v34
    s_nop 1
    v_permlane32_swap_b32 v34, v31
    s_nop 1
    v_max_f32 v34, v34, v31
    v_mov_b32 v31, v34
    s_nop 1
    v_permlane16_swap_b32 v34, v31
    s_nop 1
    v_max_f32 v34, v34, v31
    v_mul_f32 v32, s30, v32
    v_max_f32 v32, v32, v22
    v_sub_f32 v36, v22, v32
    v_exp_f32 v36, v36
    v_mov_b32 v22, v32
    v_mul_f32 v25, v25, v36
    v_mul_f32 v88, v88, v36
    v_mul_f32 v89, v89, v36
    v_mul_f32 v90, v90, v36
    v_mul_f32 v91, v91, v36
    v_mul_f32 v100, v100, v36
    v_mul_f32 v101, v101, v36
    v_mul_f32 v102, v102, v36
    v_mul_f32 v103, v103, v36
    v_mul_f32 v112, v112, v36
    v_mul_f32 v113, v113, v36
    v_mul_f32 v114, v114, v36
    v_mul_f32 v115, v115, v36
    v_mul_f32 v124, v124, v36
    v_mul_f32 v125, v125, v36
    v_mul_f32 v126, v126, v36
    v_mul_f32 v127, v127, v36
    v_mul_f32 v136, v136, v36
    v_mul_f32 v137, v137, v36
    v_mul_f32 v138, v138, v36
    v_mul_f32 v139, v139, v36
    v_mul_f32 v148, v148, v36
    v_mul_f32 v149, v149, v36
    v_mul_f32 v150, v150, v36
    v_mul_f32 v151, v151, v36
    v_mul_f32 v160, v160, v36
    v_mul_f32 v161, v161, v36
    v_mul_f32 v162, v162, v36
    v_mul_f32 v163, v163, v36
    v_mul_f32 v172, v172, v36
    v_mul_f32 v173, v173, v36
    v_mul_f32 v174, v174, v36
    v_mul_f32 v175, v175, v36
    v_mul_f32 v33, s30, v33
    v_max_f32 v33, v33, v23
    v_sub_f32 v37, v23, v33
    v_exp_f32 v37, v37
    v_mov_b32 v23, v33
    v_mul_f32 v26, v26, v37
    v_mul_f32 v92, v92, v37
    v_mul_f32 v93, v93, v37
    v_mul_f32 v94, v94, v37
    v_mul_f32 v95, v95, v37
    v_mul_f32 v104, v104, v37
    v_mul_f32 v105, v105, v37
    v_mul_f32 v106, v106, v37
    v_mul_f32 v107, v107, v37
    v_mul_f32 v116, v116, v37
    v_mul_f32 v117, v117, v37
    v_mul_f32 v118, v118, v37
    v_mul_f32 v119, v119, v37
    v_mul_f32 v128, v128, v37
    v_mul_f32 v129, v129, v37
    v_mul_f32 v130, v130, v37
    v_mul_f32 v131, v131, v37
    v_mul_f32 v140, v140, v37
    v_mul_f32 v141, v141, v37
    v_mul_f32 v142, v142, v37
    v_mul_f32 v143, v143, v37
    v_mul_f32 v152, v152, v37
    v_mul_f32 v153, v153, v37
    v_mul_f32 v154, v154, v37
    v_mul_f32 v155, v155, v37
    v_mul_f32 v164, v164, v37
    v_mul_f32 v165, v165, v37
    v_mul_f32 v166, v166, v37
    v_mul_f32 v167, v167, v37
    v_mul_f32 v176, v176, v37
    v_mul_f32 v177, v177, v37
    v_mul_f32 v178, v178, v37
    v_mul_f32 v179, v179, v37
    v_mul_f32 v34, s30, v34
    v_max_f32 v34, v34, v24
    v_sub_f32 v38, v24, v34
    v_exp_f32 v38, v38
    v_mov_b32 v24, v34
    v_mul_f32 v27, v27, v38
    v_mul_f32 v96, v96, v38
    v_mul_f32 v97, v97, v38
    v_mul_f32 v98, v98, v38
    v_mul_f32 v99, v99, v38
    v_mul_f32 v108, v108, v38
    v_mul_f32 v109, v109, v38
    v_mul_f32 v110, v110, v38
    v_mul_f32 v111, v111, v38
    v_mul_f32 v120, v120, v38
    v_mul_f32 v121, v121, v38
    v_mul_f32 v122, v122, v38
    v_mul_f32 v123, v123, v38
    v_mul_f32 v132, v132, v38
    v_mul_f32 v133, v133, v38
    v_mul_f32 v134, v134, v38
    v_mul_f32 v135, v135, v38
    v_mul_f32 v144, v144, v38
    v_mul_f32 v145, v145, v38
    v_mul_f32 v146, v146, v38
    v_mul_f32 v147, v147, v38
    v_mul_f32 v156, v156, v38
    v_mul_f32 v157, v157, v38
    v_mul_f32 v158, v158, v38
    v_mul_f32 v159, v159, v38
    v_mul_f32 v168, v168, v38
    v_mul_f32 v169, v169, v38
    v_mul_f32 v170, v170, v38
    v_mul_f32 v171, v171, v38
    v_mul_f32 v180, v180, v38
    v_mul_f32 v181, v181, v38
    v_mul_f32 v182, v182, v38
    v_mul_f32 v183, v183, v38
    s_mov_b32 s31, 0x7f800000
    s_branch SM_AF
SLOW_BL:
    v_max3_f32 v32, v184, v185, v186
    v_max3_f32 v32, v32, v187, v196
    v_max3_f32 v32, v32, v197, v198
    v_max_f32 v32, v32, v199
    v_max3_f32 v33, v188, v189, v190
    v_max3_f32 v33, v33, v191, v200
    v_max3_f32 v33, v33, v201, v202
    v_max_f32 v33, v33, v203
    v_max3_f32 v34, v192, v193, v194
    v_max3_f32 v34, v34, v195, v204
    v_max3_f32 v34, v34, v205, v206
    v_max_f32 v34, v34, v207
    v_mov_b32 v31, v32
    s_nop 1
    v_permlane32_swap_b32 v32, v31
    s_nop 1
    v_max_f32 v32, v32, v31
    v_mov_b32 v31, v32
    s_nop 1
    v_permlane16_swap_b32 v32, v31
    s_nop 1
    v_max_f32 v32, v32, v31
    v_mov_b32 v31, v33
    s_nop 1
    v_permlane32_swap_b32 v33, v31
    s_nop 1
    v_max_f32 v33, v33, v31
    v_mov_b32 v31, v33
    s_nop 1
    v_permlane16_swap_b32 v33, v31
    s_nop 1
    v_max_f32 v33, v33, v31
    v_mov_b32 v31, v34
    s_nop 1
    v_permlane32_swap_b32 v34, v31
    s_nop 1
    v_max_f32 v34, v34, v31
    v_mov_b32 v31, v34
    s_nop 1
    v_permlane16_swap_b32 v34, v31
    s_nop 1
    v_max_f32 v34, v34, v31
    v_mul_f32 v32, s30, v32
    v_max_f32 v32, v32, v22
    v_sub_f32 v36, v22, v32
    v_exp_f32 v36, v36
    v_mov_b32 v22, v32
    v_mul_f32 v25, v25, v36
    v_mul_f32 v88, v88, v36
    v_mul_f32 v89, v89, v36
    v_mul_f32 v90, v90, v36
    v_mul_f32 v91, v91, v36
    v_mul_f32 v100, v100, v36
    v_mul_f32 v101, v101, v36
    v_mul_f32 v102, v102, v36
    v_mul_f32 v103, v103, v36
    v_mul_f32 v112, v112, v36
    v_mul_f32 v113, v113, v36
    v_mul_f32 v114, v114, v36
    v_mul_f32 v115, v115, v36
    v_mul_f32 v124, v124, v36
    v_mul_f32 v125, v125, v36
    v_mul_f32 v126, v126, v36
    v_mul_f32 v127, v127, v36
    v_mul_f32 v136, v136, v36
    v_mul_f32 v137, v137, v36
    v_mul_f32 v138, v138, v36
    v_mul_f32 v139, v139, v36
    v_mul_f32 v148, v148, v36
    v_mul_f32 v149, v149, v36
    v_mul_f32 v150, v150, v36
    v_mul_f32 v151, v151, v36
    v_mul_f32 v160, v160, v36
    v_mul_f32 v161, v161, v36
    v_mul_f32 v162, v162, v36
    v_mul_f32 v163, v163, v36
    v_mul_f32 v172, v172, v36
    v_mul_f32 v173, v173, v36
    v_mul_f32 v174, v174, v36
    v_mul_f32 v175, v175, v36
    v_mul_f32 v33, s30, v33
    v_max_f32 v33, v33, v23
    v_sub_f32 v37, v23, v33
    v_exp_f32 v37, v37
    v_mov_b32 v23, v33
    v_mul_f32 v26, v26, v37
    v_mul_f32 v92, v92, v37
    v_mul_f32 v93, v93, v37
    v_mul_f32 v94, v94, v37
    v_mul_f32 v95, v95, v37
    v_mul_f32 v104, v104, v37
    v_mul_f32 v105, v105, v37
    v_mul_f32 v106, v106, v37
    v_mul_f32 v107, v107, v37
    v_mul_f32 v116, v116, v37
    v_mul_f32 v117, v117, v37
    v_mul_f32 v118, v118, v37
    v_mul_f32 v119, v119, v37
    v_mul_f32 v128, v128, v37
    v_mul_f32 v129, v129, v37
    v_mul_f32 v130, v130, v37
    v_mul_f32 v131, v131, v37
    v_mul_f32 v140, v140, v37
    v_mul_f32 v141, v141, v37
    v_mul_f32 v142, v142, v37
    v_mul_f32 v143, v143, v37
    v_mul_f32 v152, v152, v37
    v_mul_f32 v153, v153, v37
    v_mul_f32 v154, v154, v37
    v_mul_f32 v155, v155, v37
    v_mul_f32 v164, v164, v37
    v_mul_f32 v165, v165, v37
    v_mul_f32 v166, v166, v37
    v_mul_f32 v167, v167, v37
    v_mul_f32 v176, v176, v37
    v_mul_f32 v177, v177, v37
    v_mul_f32 v178, v178, v37
    v_mul_f32 v179, v179, v37
    v_mul_f32 v34, s30, v34
    v_max_f32 v34, v34, v24
    v_sub_f32 v38, v24, v34
    v_exp_f32 v38, v38
    v_mov_b32 v24, v34
    v_mul_f32 v27, v27, v38
    v_mul_f32 v96, v96, v38
    v_mul_f32 v97, v97, v38
    v_mul_f32 v98, v98, v38
    v_mul_f32 v99, v99, v38
    v_mul_f32 v108, v108, v38
    v_mul_f32 v109, v109, v38
    v_mul_f32 v110, v110, v38
    v_mul_f32 v111, v111, v38
    v_mul_f32 v120, v120, v38
    v_mul_f32 v121, v121, v38
    v_mul_f32 v122, v122, v38
    v_mul_f32 v123, v123, v38
    v_mul_f32 v132, v132, v38
    v_mul_f32 v133, v133, v38
    v_mul_f32 v134, v134, v38
    v_mul_f32 v135, v135, v38
    v_mul_f32 v144, v144, v38
    v_mul_f32 v145, v145, v38
    v_mul_f32 v146, v146, v38
    v_mul_f32 v147, v147, v38
    v_mul_f32 v156, v156, v38
    v_mul_f32 v157, v157, v38
    v_mul_f32 v158, v158, v38
    v_mul_f32 v159, v159, v38
    v_mul_f32 v168, v168, v38
    v_mul_f32 v169, v169, v38
    v_mul_f32 v170, v170, v38
    v_mul_f32 v171, v171, v38
    v_mul_f32 v180, v180, v38
    v_mul_f32 v181, v181, v38
    v_mul_f32 v182, v182, v38
    v_mul_f32 v183, v183, v38
    s_mov_b32 s31, 0x7f800000
    s_branch SM_BL
SLOW_BF:
    v_max3_f32 v32, v184, v185, v186
    v_max3_f32 v32, v32, v187, v196
    v_max3_f32 v32, v32, v197, v198
    v_max_f32 v32, v32, v199
    v_max3_f32 v33, v188, v189, v190
    v_max3_f32 v33, v33, v191, v200
    v_max3_f32 v33, v33, v201, v202
    v_max_f32 v33, v33, v203
    v_max3_f32 v34, v192, v193, v194
    v_max3_f32 v34, v34, v195, v204
    v_max3_f32 v34, v34, v205, v206
    v_max_f32 v34, v34, v207
    v_mov_b32 v31, v32
    s_nop 1
    v_permlane32_swap_b32 v32, v31
    s_nop 1
    v_max_f32 v32, v32, v31
    v_mov_b32 v31, v32
    s_nop 1
    v_permlane16_swap_b32 v32, v31
    s_nop 1
    v_max_f32 v32, v32, v31
    v_mov_b32 v31, v33
    s_nop 1
    v_permlane32_swap_b32 v33, v31
    s_nop 1
    v_max_f32 v33, v33, v31
    v_mov_b32 v31, v33
    s_nop 1
    v_permlane16_swap_b32 v33, v31
    s_nop 1
    v_max_f32 v33, v33, v31
    v_mov_b32 v31, v34
    s_nop 1
    v_permlane32_swap_b32 v34, v31
    s_nop 1
    v_max_f32 v34, v34, v31
    v_mov_b32 v31, v34
    s_nop 1
    v_permlane16_swap_b32 v34, v31
    s_nop 1
    v_max_f32 v34, v34, v31
    v_mul_f32 v32, s30, v32
    v_max_f32 v32, v32, v22
    v_sub_f32 v36, v22, v32
    v_exp_f32 v36, v36
    v_mov_b32 v22, v32
    v_mul_f32 v25, v25, v36
    v_mul_f32 v88, v88, v36
    v_mul_f32 v89, v89, v36
    v_mul_f32 v90, v90, v36
    v_mul_f32 v91, v91, v36
    v_mul_f32 v100, v100, v36
    v_mul_f32 v101, v101, v36
    v_mul_f32 v102, v102, v36
    v_mul_f32 v103, v103, v36
    v_mul_f32 v112, v112, v36
    v_mul_f32 v113, v113, v36
    v_mul_f32 v114, v114, v36
    v_mul_f32 v115, v115, v36
    v_mul_f32 v124, v124, v36
    v_mul_f32 v125, v125, v36
    v_mul_f32 v126, v126, v36
    v_mul_f32 v127, v127, v36
    v_mul_f32 v136, v136, v36
    v_mul_f32 v137, v137, v36
    v_mul_f32 v138, v138, v36
    v_mul_f32 v139, v139, v36
    v_mul_f32 v148, v148, v36
    v_mul_f32 v149, v149, v36
    v_mul_f32 v150, v150, v36
    v_mul_f32 v151, v151, v36
    v_mul_f32 v160, v160, v36
    v_mul_f32 v161, v161, v36
    v_mul_f32 v162, v162, v36
    v_mul_f32 v163, v163, v36
    v_mul_f32 v172, v172, v36
    v_mul_f32 v173, v173, v36
    v_mul_f32 v174, v174, v36
    v_mul_f32 v175, v175, v36
    v_mul_f32 v33, s30, v33
    v_max_f32 v33, v33, v23
    v_sub_f32 v37, v23, v33
    v_exp_f32 v37, v37
    v_mov_b32 v23, v33
    v_mul_f32 v26, v26, v37
    v_mul_f32 v92, v92, v37
    v_mul_f32 v93, v93, v37
    v_mul_f32 v94, v94, v37
    v_mul_f32 v95, v95, v37
    v_mul_f32 v104, v104, v37
    v_mul_f32 v105, v105, v37
    v_mul_f32 v106, v106, v37
    v_mul_f32 v107, v107, v37
    v_mul_f32 v116, v116, v37
    v_mul_f32 v117, v117, v37
    v_mul_f32 v118, v118, v37
    v_mul_f32 v119, v119, v37
    v_mul_f32 v128, v128, v37
    v_mul_f32 v129, v129, v37
    v_mul_f32 v130, v130, v37
    v_mul_f32 v131, v131, v37
    v_mul_f32 v140, v140, v37
    v_mul_f32 v141, v141, v37
    v_mul_f32 v142, v142, v37
    v_mul_f32 v143, v143, v37
    v_mul_f32 v152, v152, v37
    v_mul_f32 v153, v153, v37
    v_mul_f32 v154, v154, v37
    v_mul_f32 v155, v155, v37
    v_mul_f32 v164, v164, v37
    v_mul_f32 v165, v165, v37
    v_mul_f32 v166, v166, v37
    v_mul_f32 v167, v167, v37
    v_mul_f32 v176, v176, v37
    v_mul_f32 v177, v177, v37
    v_mul_f32 v178, v178, v37
    v_mul_f32 v179, v179, v37
    v_mul_f32 v34, s30, v34
    v_max_f32 v34, v34, v24
    v_sub_f32 v38, v24, v34
    v_exp_f32 v38, v38
    v_mov_b32 v24, v34
    v_mul_f32 v27, v27, v38
    v_mul_f32 v96, v96, v38
    v_mul_f32 v97, v97, v38
    v_mul_f32 v98, v98, v38
    v_mul_f32 v99, v99, v38
    v_mul_f32 v108, v108, v38
    v_mul_f32 v109, v109, v38
    v_mul_f32 v110, v110, v38
    v_mul_f32 v111, v111, v38
    v_mul_f32 v120, v120, v38
    v_mul_f32 v121, v121, v38
    v_mul_f32 v122, v122, v38
    v_mul_f32 v123, v123, v38
    v_mul_f32 v132, v132, v38
    v_mul_f32 v133, v133, v38
    v_mul_f32 v134, v134, v38
    v_mul_f32 v135, v135, v38
    v_mul_f32 v144, v144, v38
    v_mul_f32 v145, v145, v38
    v_mul_f32 v146, v146, v38
    v_mul_f32 v147, v147, v38
    v_mul_f32 v156, v156, v38
    v_mul_f32 v157, v157, v38
    v_mul_f32 v158, v158, v38
    v_mul_f32 v159, v159, v38
    v_mul_f32 v168, v168, v38
    v_mul_f32 v169, v169, v38
    v_mul_f32 v170, v170, v38
    v_mul_f32 v171, v171, v38
    v_mul_f32 v180, v180, v38
    v_mul_f32 v181, v181, v38
    v_mul_f32 v182, v182, v38
    v_mul_f32 v183, v183, v38
    s_mov_b32 s31, 0x7f800000
    s_branch SM_BF
.section .rodata,"a"
.p2align 6
.amdhsa_kernel concat_heads__gqa_block_cached__mha_block_cached__near_ridge_kernel
  .amdhsa_next_free_vgpr 256
  .amdhsa_next_free_sgpr 100
  .amdhsa_accum_offset 256
  .amdhsa_group_segment_fixed_size 0
  .amdhsa_kernarg_size 104
  .amdhsa_user_sgpr_count 2
  .amdhsa_user_sgpr_kernarg_segment_ptr 1
  .amdhsa_system_sgpr_workgroup_id_x 1
.end_amdhsa_kernel
```
